```python
import torch

def _softmax(x, axis=-1):
    return torch.softmax(x, dim=axis)
def _gelu(x):
    return torch.nn.functional.gelu(x, approximate="tanh")
def _silu(x):
    return torch.nn.functional.silu(x)
def _sigmoid(x):
    return torch.sigmoid(x)
def _layernorm(x, axis=-1, eps=1e-5):
    m = x.mean(dim=axis, keepdim=True)
    v = x.var(dim=axis, keepdim=True, unbiased=False)
    return (x - m) / torch.sqrt(v + eps)
def _scatter_add(tgt, idx, src, axis=0):
    return tgt.clone().index_add_(axis, idx, src)
def _segment_sum(src, seg, n):
    out = torch.zeros((n,) + src.shape[1:], dtype=src.dtype)
    return out.index_add_(0, seg, src)
def _pad(x, pw):
    flat = tuple(v for pair in reversed(pw) for v in pair)
    return torch.nn.functional.pad(x, flat)

kernel_name = 'parallel_sum__sliding_block__glu_gated_reglu__prompt'

def setup_inputs():

    _w = (lambda a: (lambda t: t.to(torch.bfloat16) if t.is_floating_point() else t)(torch.as_tensor(a)))
    def _A_setup():
        B, S, D = 1, 2048, 640
        return {
            "x": _w((lambda *s: torch.randn(*s, dtype=torch.bfloat16) * 0.05)(B, S, D)),
            "wqkv": _w((lambda *s: torch.randn(*s, dtype=torch.bfloat16) * 0.05)(D, 3 * D)),
            "wo": _w((lambda *s: torch.randn(*s, dtype=torch.bfloat16) * 0.05)(D, D)),
        }
    _A_in = _A_setup()

    def _B_setup():
        B, S, D, F = 1, 2048, 640, 1536
        return {
            "x": _w((lambda *s: torch.randn(*s, dtype=torch.bfloat16) * 0.05)(B, S, D)),
            "W_gate": _w((lambda *s: torch.randn(*s, dtype=torch.bfloat16) * 0.8)(D, F) * (2.0 / D) ** 0.5),
            "W_up": _w((lambda *s: torch.randn(*s, dtype=torch.bfloat16) * 0.8)(D, F) * (2.0 / D) ** 0.5),
            "W_down": _w((lambda *s: torch.randn(*s, dtype=torch.bfloat16) * 0.8)(F, D) * (1.0 / F) ** 0.5),
        }
    _B_in = _B_setup()

    return {
        "A_x": _A_in["x"],
        "A_wqkv": _A_in["wqkv"],
        "A_wo": _A_in["wo"],
        "B_x": _B_in["x"],
        "B_W_gate": _B_in["W_gate"],
        "B_W_up": _B_in["W_up"],
        "B_W_down": _B_in["W_down"],
    }

def reference(A_x, A_wqkv, A_wo, B_x, B_W_gate, B_W_up, B_W_down):
    def _A_ref(x, wqkv, wo):
        B, S, D = x.shape
        H = 32; Dh = D // H; W = 256
        qkv = (lambda x, *d: x.permute(*d))((x @ wqkv).reshape(B, S, 3, H, Dh), 2, 0, 3, 1, 4)
        q, k, v = qkv[0], qkv[1], qkv[2]
        scores = torch.einsum("bhqd,bhkd->bhqk", q, k) * (Dh ** -0.5)
        idx = torch.arange(S)
        mask = (idx[:, None] - idx[None, :] >= 0) & (idx[:, None] - idx[None, :] < W)
        scores = torch.where(mask[None, None], scores, -1e9)
        p = _softmax(scores, axis=-1)
        o = torch.einsum("bhqk,bhkd->bhqd", p, v)
        return (lambda x, *d: x.permute(*d))(o, 0, 2, 1, 3).reshape(B, S, D) @ wo

    def _B_ref(x, W_gate, W_up, W_down):
        gate = torch.einsum("bsd,df->bsf", x, W_gate)
        up = torch.einsum("bsd,df->bsf", x, W_up)
        gate = gate * (lambda x, dt: x.to(dt))(gate > 0, gate.dtype)
        h = gate * up
        return torch.einsum("bsf,fd->bsd", h, W_down)

    x = A_x
    xn = _layernorm(x, axis=-1)
    return x + _A_ref(xn, A_wqkv, A_wo) + _B_ref(xn, B_W_gate, B_W_up, B_W_down)
```

```asm
; @launch grid=(256,1,1) block=(512,1,1) lds=163840
.amdgcn_target "amdgcn-amd-amdhsa--gfx950"
.text
.globl parallel_sum__sliding_block__glu_gated_reglu__prompt_kernel
.p2align 8
.type parallel_sum__sliding_block__glu_gated_reglu__prompt_kernel,@function
.set CODE_SPAN, L_fin - parallel_sum__sliding_block__glu_gated_reglu__prompt_kernel - 128
parallel_sum__sliding_block__glu_gated_reglu__prompt_kernel:
    s_getpc_b64 s[78:79]
    s_lshr_b32 s48, s2, 3
    s_lshl_b32 s49, s48, 11
    v_lshrrev_b32 v2, 5, v0
    v_lshl_add_u32 v2, v2, 7, s49
    v_min_u32 v2, CODE_SPAN, v2
    s_cmp_ge_u32 s2, 256
    s_cbranch_scc1 L_end
    v_mov_b32 v3, s79
    v_add_co_u32 v2, vcc, s78, v2
    s_nop 1
    v_addc_co_u32 v3, vcc, 0, v3, vcc
    global_load_dword v255, v[2:3], off
    s_load_dwordx16 s[56:71], s[0:1], 0
    s_load_dwordx4 s[72:75], s[0:1], 64
    s_memrealtime s[76:77]
    v_lshrrev_b32 v1, 6, v0
    v_and_b32 v224, 63, v0
    s_and_b32 s47, s2, 7
    v_readfirstlane_b32 s3, v1
    s_and_b32 s49, s48, 7
    s_lshr_b32 s50, s48, 3
    s_and_b32 s38, s47, 1
    s_lshl3_add_u32 s38, s38, s49
    s_lshr_b32 s39, s47, 1
    s_lshl2_add_u32 s39, s39, s50
    s_lshr_b32 s43, s39, 1
    s_add_u32 s43, s43, s38
    s_mul_i32 s51, s43, 52
    s_lshr_b32 s51, s51, 8
    s_mul_i32 s51, s51, 5
    s_sub_u32 s43, s43, s51
    s_lshl_b32 s43, s43, 1
    v_lshrrev_b32 v2, 3, v0
    v_lshrrev_b32 v3, 4, v0
    v_xor_b32 v4, v3, v0
    v_and_b32 v4, 7, v4
    v_lshlrev_b32 v4, 4, v4
    s_mul_i32 s51, s38, 163840
    v_mul_u32_u24 v5, 1280, v2
    s_lshl_b32 s44, s3, 10
    s_lshl_b32 s40, s43, 7
    v_add3_u32 v84, v4, v5, s51
    s_mov_b32 s6, 2621440
    s_mov_b32 s7, 0x00020000
    v_lshlrev_b32 v3, 2, v3
    v_xor_b32 v3, v3, v0
    v_and_b32 v3, 7, v3
    v_lshlrev_b32 v3, 4, v3
    s_lshl_b32 s51, s39, 8
    v_mul_u32_u24 v5, 3840, v2
    s_mul_i32 s41, s43, 245760
    v_add3_u32 v86, v3, v5, s51
    v_add_u32 v85, 81920, v84
    s_cmp_eq_u32 s39, 15
    s_cselect_b32 s10, 0, 2457600
    s_mov_b32 s11, 0x00020000
    s_waitcnt lgkmcnt(0)
    s_mov_b64 s[4:5], s[56:57]
    s_mov_b64 s[8:9], s[58:59]
    s_mov_b64 s[32:33], s[72:73]
    s_mov_b32 s34, 256
    s_mov_b32 s35, 0x00020000
    s_or_b32 s51, s2, s3
    s_cmp_lg_u32 s51, 0
    s_cbranch_scc1 L_nt
    s_or_b32 s52, s76, 1
    v_mov_b32 v5, s52
    buffer_store_dword v5, off, s[32:35], 0 offset:128 sc1
L_nt:
    s_add_u32 m0, s44, 84608
    s_nop 0
    buffer_load_dwordx4 v84, s[4:7], s40 offen lds
    s_add_u32 m0, s44, 2048
    s_nop 0
    buffer_load_dwordx4 v86, s[8:11], s41 offen lds
    s_add_u32 m0, s44, 92800
    s_nop 0
    buffer_load_dwordx4 v85, s[4:7], s40 offen lds
    s_add_u32 m0, s44, 10144
    s_nop 0
    buffer_load_dwordx4 v86, s[8:11], s41 offen offset:128 lds
    s_and_b32 s36, s3, 3
    s_lshr_b32 s37, s3, 2
    s_mul_i32 s51, s39, 192
    s_and_b32 s52, s39, 1
    s_lshl_b32 s52, s52, 6
    s_add_u32 s51, s51, s52
    v_mul_u32_u24 v5, 3072, v2
    v_add3_u32 v5, v3, v5, s51
    v_lshlrev_b32 v0, 4, v224
    s_lshl4_add_u32 s51, s38, s39
    s_lshl3_add_u32 s95, s51, s3
    v_mov_b32 v244, 0
    v_mov_b32 v245, 0
    v_mov_b32 v246, 0
    v_mov_b32 v247, 0
    s_lshl2_add_u32 s46, s38, s36
    s_mul_i32 s42, s43, 196608
    v_lshrrev_b32 v1, 5, v224
    v_lshlrev_b32 v1, 10, v1
    v_bfe_u32 v2, v224, 2, 2
    v_lshl_add_u32 v1, v2, 7, v1
    v_lshrrev_b32 v2, 1, v2
    v_xor_b32 v2, s37, v2
    v_lshl_add_u32 v1, v2, 6, v1
    v_and_b32 v3, 3, v224
    v_lshl_add_u32 v1, v3, 3, v1
    v_lshl_add_u32 v1, s36, 11, v1
    v_bfe_u32 v44, v224, 4, 1
    v_mul_u32_u24 v44, 8224, v44
    v_add_u32 v44, 2048, v44
    v_xor_b32 v2, 2048, v1
    v_xor_b32 v3, 4096, v1
    v_xor_b32 v4, 6144, v1
    v_add_u32 v1, v1, v44
    v_add_u32 v2, v2, v44
    v_add_u32 v3, v3, v44
    v_add_u32 v4, v4, v44
    v_bfe_u32 v44, v224, 1, 3
    v_lshrrev_b32 v45, 5, v224
    v_xor_b32 v44, v44, v45
    s_lshl_b32 s51, s36, 1
    v_xor_b32 v44, s51, v44
    v_lshlrev_b32 v44, 4, v44
    v_and_b32 v45, 31, v224
    v_lshl_add_u32 v44, v45, 7, v44
    s_lshl_b32 s51, s36, 12
    s_add_u32 s51, s51, 84608
    v_add_u32 v80, s51, v44
    v_xor_b32 v81, 32, v80
    v_xor_b32 v82, 64, v80
    v_xor_b32 v83, 96, v80
    v_lshrrev_b32 v44, 2, v224
    v_and_b32 v44, 8, v44
    v_xor_b32 v44, v44, v224
    v_and_b32 v44, 14, v44
    v_cmp_eq_u32 vcc, 0, v44
    v_mov_b32 v45, 0x3f803f80
    s_nop 0
    v_cndmask_b32 v8, 0, v45, vcc
    v_cndmask_b32 v9, 0, v45, vcc
    v_cmp_eq_u32 vcc, 4, v44
    v_mov_b32 v12, 0
    v_mov_b32 v13, 0
    v_cndmask_b32 v10, 0, v45, vcc
    v_cndmask_b32 v11, 0, v45, vcc
    v_bfe_i32 v16, v0, 4, 1
    v_and_b32 v16, 0xaaaa, v16
    v_or_b32 v16, 0x4444, v16
    s_mov_b64 s[20:21], s[74:75]
    s_mov_b32 s22, 23191552
    s_mov_b32 s23, 0x00020000
    s_mov_b64 s[12:13], s[64:65]
    s_mov_b32 s14, 1966080
    s_mov_b32 s15, 0x00020000
    s_mov_b64 s[16:17], s[66:67]
    s_mov_b32 s18, 1966080
    s_mov_b32 s19, 0x00020000
    s_mov_b32 s90, 0
    s_mov_b32 s91, -1
    s_mul_i32 s47, s39, 205
    s_lshr_b32 s47, s47, 10
    s_mul_i32 s48, s47, 5
    s_sub_u32 s48, s39, s48
    s_lshl2_add_u32 s48, s48, s37
    s_lshl_b32 s92, s48, 2
    s_mul_i32 s48, s46, 3
    s_add_u32 s47, s47, s48
    s_mul_i32 s93, s47, 2560
    s_lshr_b32 s47, s46, 1
    s_mul_i32 s55, s47, 278784
    s_lshr_b32 s47, s39, 2
    s_mul_i32 s47, s47, 69632
    s_add_u32 s55, s55, s47
    s_and_b32 s47, s36, 1
    s_lshl_b32 s47, s47, 11
    s_add_u32 s55, s55, s47
    s_add_u32 s55, s55, 7866368
    s_lshl_b32 s51, s46, 9
    s_add_u32 s51, s51, 21553152
    v_and_b32 v90, 0x1f0, v0
    v_lshl_add_u32 v90, v90, 0, s51
    s_add_u32 m0, s44, 101120
    s_add_u32 s40, s40, 128
    s_cmp_eq_u32 s40, 1280
    s_cselect_b32 s40, 0, s40
    buffer_load_dwordx4 v84, s[4:7], s40 offen lds
    s_add_u32 m0, s44, 109312
    s_nop 0
    buffer_load_dwordx4 v85, s[4:7], s40 offen lds
    s_add_u32 m0, s44, 18560
    s_add_u32 s41, s41, 245760
    s_cmp_eq_u32 s41, 2457600
    s_cselect_b32 s41, 0, s41
    buffer_load_dwordx4 v86, s[8:11], s41 offen lds
    s_add_u32 m0, s44, 26656
    s_nop 0
    buffer_load_dwordx4 v86, s[8:11], s41 offen offset:128 lds
    s_lshr_b32 s48, s3, 1
    s_lshl_b32 s48, s48, 8
    s_add_u32 s47, s2, s48
    s_cmp_lt_u32 s47, 680
    s_cselect_b32 s43, 1, 0
    s_and_b32 s99, s3, 1
    s_mul_i32 s48, s47, 6554
    s_lshr_b32 s48, s48, 16
    s_mul_i32 s49, s48, 10
    s_sub_u32 s49, s47, s49
    s_mul_i32 s50, s48, 241
    s_lshr_b32 s50, s50, 12
    s_mul_i32 s51, s50, 17
    s_sub_u32 s51, s48, s51
    s_mul_i32 s96, s48, 5
    s_lshl1_add_u32 s48, s49, s99
    s_lshl_b32 s48, s48, 1
    s_mul_i32 s88, s48, 205
    s_lshr_b32 s88, s88, 10
    s_add_u32 s52, s48, 1
    s_mul_i32 s89, s52, 205
    s_lshr_b32 s89, s89, 10
    s_mul_i32 s88, s88, 343168
    s_mul_i32 s89, s89, 343168
    s_add_u32 s48, s48, s96
    s_lshl_b32 s48, s48, 10
    s_add_u32 s48, s48, 16787456
    s_add_u32 s88, s88, s48
    s_add_u32 s89, s89, s48
    s_add_u32 s89, s89, 1024
    s_mov_b32 s78, 3128316944
    s_mov_b32 s79, 38962
    s_lshl_b32 s48, s51, 2
    s_lshr_b64 s[78:79], s[78:79], s48
    s_and_b32 s78, s78, 15
    s_mul_i32 s96, s50, 12
    s_add_u32 s96, s96, s78
    s_lshl_b32 s96, s96, 5
    s_and_b32 s78, s51, 1
    s_mul_i32 s78, s78, 80
    s_bfe_u32 s79, s51, 0x10001
    s_mul_i32 s79, s79, 24
    s_add_u32 s78, s78, s79
    s_mul_i32 s48, s50, 160
    s_cmp_eq_u32 s51, 16
    s_cmov_b32 s78, 16
    s_cselect_b32 s52, 80, 40
    s_cselect_b32 s97, 4, 8
    s_cselect_b32 s98, 40, 4
    s_add_u32 s48, s48, s78
    s_cmp_ge_u32 s51, 12
    s_cselect_b32 s96, s48, s96
    s_cselect_b32 s52, s52, 16
    s_cselect_b64 s[28:29], s[60:61], s[68:69]
    s_mov_b32 s30, 1966080
    s_cmov_b32 s30, 819200
    s_mov_b32 s31, 0x00020000
    s_lshl_b32 s49, s49, 7
    s_mul_i32 s52, s52, s99
    s_add_u32 s96, s96, s52
    s_mul_i32 s96, s96, 1280
    s_add_u32 s96, s96, s49
    s_mul_i32 s97, s97, 1280
    s_add_u32 s97, s97, s96
    s_lshr_b32 s51, s3, 1
    s_lshl_b32 s51, s51, 6
    s_add_u32 s51, s51, s99
    s_lshl_b32 s51, s51, 6
    s_add_u32 s99, s51, 150656
    s_cmp_eq_u32 s43, 0
    s_cmov_b32 s30, 0
    s_cmov_b32 s88, 0x7ffffff0
    s_cmov_b32 s89, 0x7ffffff0
    s_lshl1_add_u32 s43, s44, 150656
    s_cmp_ge_u32 s3, 6
    s_cmov_b32 s99, 150656
    v_lshrrev_b32 v44, 9, v0
    v_bfe_u32 v45, v0, 7, 2
    v_mad_u32_u24 v45, v44, s98, v45
    v_and_b32 v44, 0x70, v0
    v_mul_u32_u24 v45, 1280, v45
    v_add_u32 v45, v45, v44
    v_bfe_u32 v252, v5, 5, 1
    s_bitcmp1_b32 s39, 0
    v_mul_u32_u24 v252, 196576, v252
    s_cselect_b32 s47, 0, 0xc0
    s_lshr_b32 s48, s38, 1
    s_mul_i32 s49, s48, 393216
    s_add_u32 s47, s47, s49
    v_add3_u32 v252, v252, v5, s47
    v_bfe_u32 v253, v5, 6, 1
    v_lshl_add_u32 v253, v253, 5, 64
    v_sub_u32 v252, v252, v253
    s_mul_i32 s83, s39, 123136
    s_mul_i32 s48, s48, 24576
    s_add_u32 s83, s83, s48
    s_lshl1_add_u32 s83, s44, s83
    s_and_b32 s48, s38, 1
    s_cselect_b64 s[24:25], s[66:67], s[64:65]
    s_lshl_b32 s48, s48, 10
    s_add_u32 s83, s83, s48
    s_add_u32 s83, s83, 19582976
    s_cmp_lt_u32 s38, 10
    s_cselect_b32 s26, 1966080, 0
    s_cselect_b32 s83, s83, 0x7ffffff0
    s_mov_b32 s27, 0x00020000
    s_waitcnt vmcnt(4)
    s_barrier
    ds_read_b64_tr_b16 v[20:21], v1 offset:0
    ds_read_b64_tr_b16 v[22:23], v1 offset:512
    ds_read_b128 v[96:99], v80 offset:0
    ds_read_b64_tr_b16 v[24:25], v2 offset:0
    ds_read_b64_tr_b16 v[26:27], v2 offset:512
    ds_read_b128 v[100:103], v81 offset:0
    ds_read_b64_tr_b16 v[28:29], v3 offset:0
    ds_read_b64_tr_b16 v[30:31], v3 offset:512
    ds_read_b128 v[104:107], v82 offset:0
    ds_read_b64_tr_b16 v[32:33], v4 offset:0
    ds_read_b64_tr_b16 v[34:35], v4 offset:512
    ds_read_b128 v[108:111], v83 offset:0
    s_waitcnt lgkmcnt(9)
    v_mfma_f32_32x32x16_bf16 v[48:63], v[20:23], v[96:99], 0
    ds_read_b64_tr_b16 v[36:37], v1 offset:32
    ds_read_b64_tr_b16 v[38:39], v1 offset:544
    s_mul_i32 s0, s95, 1280
    buffer_load_dwordx4 v[240:243], v0, s[4:7], s0 offen
    s_mov_b64 exec, 0xffff
    buffer_load_dwordx4 v[244:247], v0, s[4:7], s0 offen offset:1024
    s_mov_b64 exec, -1
    s_waitcnt lgkmcnt(8)
    v_mfma_f32_32x32x16_bf16 v[48:63], v[24:27], v[100:103], v[48:63]
    ds_read_b64_tr_b16 v[20:21], v2 offset:32
    ds_read_b64_tr_b16 v[22:23], v2 offset:544
    buffer_load_dword v87, off, s[32:35], 0 offset:128 sc1
    s_waitcnt lgkmcnt(7)
    v_mfma_f32_32x32x16_bf16 v[48:63], v[28:31], v[104:107], v[48:63]
    ds_read_b64_tr_b16 v[24:25], v3 offset:32
    ds_read_b64_tr_b16 v[26:27], v3 offset:544
    s_add_u32 m0, s44, 117632
    s_add_u32 s40, s40, 128
    s_cmp_eq_u32 s40, 1280
    s_cselect_b32 s40, 0, s40
    buffer_load_dwordx4 v84, s[4:7], s40 offen lds
    s_waitcnt lgkmcnt(6)
    v_mfma_f32_32x32x16_bf16 v[48:63], v[32:35], v[108:111], v[48:63]
    ds_read_b64_tr_b16 v[28:29], v4 offset:32
    ds_read_b64_tr_b16 v[30:31], v4 offset:544
    s_add_u32 m0, s44, 125824
    s_nop 0
    buffer_load_dwordx4 v85, s[4:7], s40 offen lds
    s_waitcnt lgkmcnt(6)
    v_mfma_f32_32x32x16_bf16 v[64:79], v[36:39], v[96:99], 0
    v_smfmac_f32_16x16x64_bf16 v[12:15], v[8:11], v[32:39], v16
    s_waitcnt vmcnt(7)
    s_waitcnt vmcnt(5)
    s_barrier
    ds_read_b64_tr_b16 v[32:33], v1 offset:16512
    ds_read_b64_tr_b16 v[34:35], v1 offset:17024
    ds_read_b128 v[112:115], v80 offset:16512
    s_add_u32 m0, s44, 35072
    s_add_u32 s41, s41, 245760
    s_cmp_eq_u32 s41, 2457600
    s_cselect_b32 s41, 0, s41
    buffer_load_dwordx4 v86, s[8:11], s41 offen lds
    s_mov_b32 s84, 0x3f803f80
    v_mov_b32 v225, 0
    v_mov_b32 v226, 0
    s_waitcnt vmcnt(5)
    v_dot2c_f32_bf16 v225, s84, v240
    v_dot2c_f32_bf16 v226, v240, v240
    s_waitcnt lgkmcnt(7)
    v_mfma_f32_32x32x16_bf16 v[64:79], v[20:23], v[100:103], v[64:79]
    ds_read_b64_tr_b16 v[36:37], v2 offset:16512
    ds_read_b64_tr_b16 v[38:39], v2 offset:17024
    ds_read_b128 v[116:119], v81 offset:16512
    s_add_u32 m0, s44, 43168
    s_nop 0
    buffer_load_dwordx4 v86, s[8:11], s41 offen offset:128 lds
    v_dot2c_f32_bf16 v225, s84, v241
    v_dot2c_f32_bf16 v226, v241, v241
    v_dot2c_f32_bf16 v225, s84, v242
    v_dot2c_f32_bf16 v226, v242, v242
    v_dot2c_f32_bf16 v225, s84, v243
    s_waitcnt lgkmcnt(8)
    v_mfma_f32_32x32x16_bf16 v[64:79], v[24:27], v[104:107], v[64:79]
    ds_read_b64_tr_b16 v[20:21], v3 offset:16512
    ds_read_b64_tr_b16 v[22:23], v3 offset:17024
    ds_read_b128 v[120:123], v82 offset:16512
    s_add_u32 m0, s43, 0
    s_nop 0
    buffer_load_dwordx4 v45, s[28:31], s96 offen nt lds
    v_dot2c_f32_bf16 v226, v243, v243
    s_waitcnt vmcnt(6)
    v_dot2c_f32_bf16 v225, s84, v244
    v_dot2c_f32_bf16 v226, v244, v244
    v_dot2c_f32_bf16 v225, s84, v245
    v_dot2c_f32_bf16 v226, v245, v245
    s_waitcnt lgkmcnt(9)
    v_mfma_f32_32x32x16_bf16 v[64:79], v[28:31], v[108:111], v[64:79]
    ds_read_b64_tr_b16 v[24:25], v4 offset:16512
    ds_read_b64_tr_b16 v[26:27], v4 offset:17024
    ds_read_b128 v[124:127], v83 offset:16512
    s_add_u32 m0, s43, 1024
    s_nop 0
    buffer_load_dwordx4 v45, s[28:31], s97 offen nt lds
    v_dot2c_f32_bf16 v225, s84, v246
    v_dot2c_f32_bf16 v226, v246, v246
    v_dot2c_f32_bf16 v225, s84, v247
    v_dot2c_f32_bf16 v226, v247, v247
    s_waitcnt lgkmcnt(9)
    v_mfma_f32_32x32x16_bf16 v[48:63], v[32:35], v[112:115], v[48:63]
    ds_read_b64_tr_b16 v[28:29], v1 offset:16544
    ds_read_b64_tr_b16 v[30:31], v1 offset:17056
    s_add_u32 m0, s44, 134144
    s_add_u32 s40, s40, 128
    s_cmp_eq_u32 s40, 1280
    s_cselect_b32 s40, 0, s40
    buffer_load_dwordx4 v84, s[4:7], s40 offen lds
    v_permlane32_swap_b32 v225, v226
    v_add_f32 v225, v225, v226
    s_waitcnt lgkmcnt(8)
    v_mfma_f32_32x32x16_bf16 v[48:63], v[36:39], v[116:119], v[48:63]
    ds_read_b64_tr_b16 v[32:33], v2 offset:16544
    ds_read_b64_tr_b16 v[34:35], v2 offset:17056
    s_add_u32 m0, s44, 142336
    s_nop 0
    buffer_load_dwordx4 v85, s[4:7], s40 offen lds
    v_add_f32_dpp v225, v225, v225 row_ror:1 row_mask:0xf bank_mask:0xf
    s_nop 1
    v_add_f32_dpp v225, v225, v225 row_ror:2 row_mask:0xf bank_mask:0xf
    s_waitcnt lgkmcnt(7)
    v_mfma_f32_32x32x16_bf16 v[48:63], v[20:23], v[120:123], v[48:63]
    ds_read_b64_tr_b16 v[36:37], v3 offset:16544
    ds_read_b64_tr_b16 v[38:39], v3 offset:17056
    s_add_u32 m0, s44, 51584
    s_add_u32 s41, s41, 245760
    s_cmp_eq_u32 s41, 2457600
    s_cselect_b32 s41, 0, s41
    buffer_load_dwordx4 v86, s[8:11], s41 offen lds
    v_add_f32_dpp v225, v225, v225 row_ror:4 row_mask:0xf bank_mask:0xf
    s_nop 1
    v_add_f32_dpp v225, v225, v225 row_ror:8 row_mask:0xf bank_mask:0xf
    s_waitcnt lgkmcnt(6)
    v_mfma_f32_32x32x16_bf16 v[48:63], v[24:27], v[124:127], v[48:63]
    ds_read_b64_tr_b16 v[20:21], v4 offset:16544
    ds_read_b64_tr_b16 v[22:23], v4 offset:17056
    s_add_u32 m0, s44, 59680
    s_nop 0
    buffer_load_dwordx4 v86, s[8:11], s41 offen offset:128 lds
    v_readlane_b32 s84, v225, 0
    v_readlane_b32 s85, v225, 16
    v_readlane_b32 s86, v225, 32
    v_readlane_b32 s87, v225, 48
    v_mov_b32 v225, s84
    s_waitcnt lgkmcnt(6)
    v_mfma_f32_32x32x16_bf16 v[64:79], v[28:31], v[112:115], v[64:79]
    v_smfmac_f32_16x16x64_bf16 v[12:15], v[8:11], v[24:31], v16
    s_waitcnt vmcnt(8)
    s_waitcnt vmcnt(6)
    s_barrier
    ds_read_b64_tr_b16 v[24:25], v1 offset:33024
    ds_read_b64_tr_b16 v[26:27], v1 offset:33536
    ds_read_b128 v[128:131], v80 offset:33024
    buffer_load_dwordx4 v[248:251], v252, s[24:27], 0 offen nt
    v_mov_b32 v226, s86
    v_add_f32 v225, s85, v225
    v_add_f32 v226, s87, v226
    v_mul_f32 v225, 0.0015625, v225
    v_mul_f32 v226, 0.0015625, v226
    s_waitcnt lgkmcnt(7)
    v_mfma_f32_32x32x16_bf16 v[64:79], v[32:35], v[116:119], v[64:79]
    ds_read_b64_tr_b16 v[28:29], v1 offset:33056
    ds_read_b64_tr_b16 v[30:31], v1 offset:33568
    ds_read_b128 v[132:135], v81 offset:33024
    s_add_u32 m0, s44, 68096
    s_add_u32 s41, s41, 245760
    s_cmp_eq_u32 s41, 2457600
    s_cselect_b32 s41, 0, s41
    buffer_load_dwordx4 v86, s[8:11], s41 offen lds
    v_fma_f32 v226, -v225, v225, v226
    v_max_f32 v226, 0, v226
    v_cvt_pk_bf16_f32 v226, v226, v226
    v_and_b32 v226, 0xffff0000, v226
    v_add_f32 v226, 0x3727c5ac, v226
    s_waitcnt lgkmcnt(8)
    v_mfma_f32_32x32x16_bf16 v[64:79], v[36:39], v[120:123], v[64:79]
    ds_read_b64_tr_b16 v[32:33], v2 offset:33024
    ds_read_b64_tr_b16 v[34:35], v2 offset:33536
    ds_read_b128 v[136:139], v82 offset:33024
    s_add_u32 m0, s44, 76192
    s_nop 0
    buffer_load_dwordx4 v86, s[8:11], s41 offen offset:128 lds
    v_cvt_pk_bf16_f32 v226, v226, v226
    v_and_b32 v226, 0xffff0000, v226
    v_sqrt_f32 v226, v226
    v_sub_f32 v225, 0, v225
    v_cvt_pk_bf16_f32 v88, v225, v226
    s_waitcnt lgkmcnt(9)
    v_mfma_f32_32x32x16_bf16 v[64:79], v[20:23], v[124:127], v[64:79]
    ds_read_b64_tr_b16 v[36:37], v3 offset:33024
    ds_read_b64_tr_b16 v[38:39], v3 offset:33536
    ds_read_b128 v[140:143], v83 offset:33024
    s_add_u32 m0, s44, 84608
    s_add_u32 s40, s40, 128
    s_cmp_eq_u32 s40, 1280
    s_cselect_b32 s40, 0, s40
    buffer_load_dwordx4 v84, s[4:7], s40 offen lds
    s_lshl_b32 s84, s3, 4
    v_mov_b32 v89, s84
    ds_write_b32 v89, v88 offset:0
    s_waitcnt lgkmcnt(10)
    v_mfma_f32_32x32x16_bf16 v[48:63], v[24:27], v[128:131], v[48:63]
    ds_read_b64_tr_b16 v[20:21], v4 offset:33024
    ds_read_b64_tr_b16 v[22:23], v4 offset:33536
    s_waitcnt lgkmcnt(10)
    v_mfma_f32_32x32x16_bf16 v[64:79], v[28:31], v[128:131], v[64:79]
    v_smfmac_f32_16x16x64_bf16 v[12:15], v[8:11], v[24:31], v16
    ds_read_b64_tr_b16 v[24:25], v2 offset:33056
    ds_read_b64_tr_b16 v[26:27], v2 offset:33568
    s_add_u32 m0, s44, 92800
    s_nop 0
    buffer_load_dwordx4 v85, s[4:7], s40 offen lds
    s_waitcnt lgkmcnt(9)
    v_mfma_f32_32x32x16_bf16 v[48:63], v[32:35], v[132:135], v[48:63]
    ds_read_b64_tr_b16 v[28:29], v3 offset:33056
    ds_read_b64_tr_b16 v[30:31], v3 offset:33568
    s_waitcnt lgkmcnt(8)
    v_mfma_f32_32x32x16_bf16 v[48:63], v[36:39], v[136:139], v[48:63]
    ds_read_b64_tr_b16 v[32:33], v4 offset:33056
    ds_read_b64_tr_b16 v[34:35], v4 offset:33568
    s_add_u32 m0, s44, 101120
    s_add_u32 s40, s40, 128
    s_cmp_eq_u32 s40, 1280
    s_cselect_b32 s40, 0, s40
    buffer_load_dwordx4 v84, s[4:7], s40 offen lds
    s_waitcnt lgkmcnt(6)
    v_mfma_f32_32x32x16_bf16 v[48:63], v[20:23], v[140:143], v[48:63]
    s_waitcnt vmcnt(8)
    s_waitcnt vmcnt(6)
    s_barrier
    ds_read_b64_tr_b16 v[36:37], v1 offset:49536
    ds_read_b64_tr_b16 v[38:39], v1 offset:50048
    ds_read_b128 v[144:147], v80 offset:49536
    ds_read_b32 v88, v0 offset:0
    s_add_u32 m0, s44, 2048
    s_add_u32 s41, s41, 245760
    s_cmp_eq_u32 s41, 2457600
    s_cselect_b32 s41, 0, s41
    buffer_load_dwordx4 v86, s[8:11], s41 offen lds
    s_waitcnt lgkmcnt(8)
    v_mfma_f32_32x32x16_bf16 v[64:79], v[24:27], v[132:135], v[64:79]
    ds_read_b64_tr_b16 v[20:21], v2 offset:49536
    ds_read_b64_tr_b16 v[22:23], v2 offset:50048
    ds_read_b128 v[148:151], v81 offset:49536
    s_add_u32 m0, s44, 109312
    s_nop 0
    buffer_load_dwordx4 v85, s[4:7], s40 offen lds
    s_waitcnt lgkmcnt(9)
    v_mfma_f32_32x32x16_bf16 v[64:79], v[28:31], v[136:139], v[64:79]
    ds_read_b64_tr_b16 v[24:25], v3 offset:49536
    ds_read_b64_tr_b16 v[26:27], v3 offset:50048
    ds_read_b128 v[152:155], v82 offset:49536
    s_waitcnt lgkmcnt(10)
    v_mfma_f32_32x32x16_bf16 v[64:79], v[32:35], v[140:143], v[64:79]
    ds_read_b64_tr_b16 v[28:29], v4 offset:49536
    ds_read_b64_tr_b16 v[30:31], v4 offset:50048
    ds_read_b128 v[156:159], v83 offset:49536
    s_add_u32 m0, s44, 10144
    s_nop 0
    buffer_load_dwordx4 v86, s[8:11], s41 offen offset:128 lds
    s_waitcnt lgkmcnt(10)
    v_mfma_f32_32x32x16_bf16 v[48:63], v[36:39], v[144:147], v[48:63]
    ds_read_b64_tr_b16 v[32:33], v1 offset:49568
    ds_read_b64_tr_b16 v[34:35], v1 offset:50080
    s_waitcnt lgkmcnt(8)
    v_mfma_f32_32x32x16_bf16 v[48:63], v[20:23], v[148:151], v[48:63]
    ds_read_b64_tr_b16 v[36:37], v2 offset:49568
    ds_read_b64_tr_b16 v[38:39], v2 offset:50080
    s_add_u32 m0, s44, 117632
    s_add_u32 s40, s40, 128
    s_cmp_eq_u32 s40, 1280
    s_cselect_b32 s40, 0, s40
    buffer_load_dwordx4 v84, s[4:7], s40 offen lds
    s_waitcnt lgkmcnt(7)
    v_mfma_f32_32x32x16_bf16 v[48:63], v[24:27], v[152:155], v[48:63]
    ds_read_b64_tr_b16 v[20:21], v3 offset:49568
    ds_read_b64_tr_b16 v[22:23], v3 offset:50080
    v_readfirstlane_b32 s45, v87
    s_cmp_eq_u32 s45, 0
    s_cbranch_scc1 Ltl_2_e
Ltd_1:
    s_cmp_lg_u32 s3, 0
    s_cbranch_scc1 L_nps
    v_mov_b32 v89, s45
    s_lshl4_add_u32 s84, s95, 21553152
    s_mov_b64 exec, 0xff
    buffer_store_dwordx4 v[88:91], v0, s[20:23], s84 offen sc1
    s_mov_b64 exec, -1
L_nps:
    s_waitcnt lgkmcnt(6)
    v_mfma_f32_32x32x16_bf16 v[48:63], v[28:31], v[156:159], v[48:63]
    ds_read_b64_tr_b16 v[24:25], v4 offset:49568
    ds_read_b64_tr_b16 v[26:27], v4 offset:50080
    s_add_u32 m0, s44, 18560
    s_add_u32 s41, s41, 245760
    s_cmp_eq_u32 s41, 2457600
    s_cselect_b32 s41, 0, s41
    buffer_load_dwordx4 v86, s[8:11], s41 offen lds
    s_waitcnt lgkmcnt(6)
    v_mfma_f32_32x32x16_bf16 v[64:79], v[32:35], v[144:147], v[64:79]
    v_smfmac_f32_16x16x64_bf16 v[12:15], v[8:11], v[28:35], v16
    s_waitcnt vmcnt(6)
    s_barrier
    v_add_u32 v1, 66048, v1
    ds_read_b64_tr_b16 v[28:29], v1 offset:0
    ds_read_b64_tr_b16 v[30:31], v1 offset:512
    ds_read_b128 v[160:163], v80 offset:0
    v_lshrrev_b32 v41, 9, v0
    v_lshlrev_b32 v41, 11, v41
    v_bfe_u32 v44, v0, 8, 1
    v_lshl_add_u32 v41, v44, 9, v41
    v_bfe_u32 v44, v0, 6, 2
    s_waitcnt lgkmcnt(7)
    v_mfma_f32_32x32x16_bf16 v[64:79], v[36:39], v[148:151], v[64:79]
    v_add_u32 v2, 66048, v2
    ds_read_b64_tr_b16 v[32:33], v2 offset:0
    ds_read_b64_tr_b16 v[34:35], v2 offset:512
    ds_read_b128 v[164:167], v81 offset:0
    s_add_u32 m0, s44, 125824
    s_nop 0
    buffer_load_dwordx4 v85, s[4:7], s40 offen lds
    v_lshl_add_u32 v41, v44, 7, v41
    v_bfe_u32 v44, v0, 4, 2
    v_lshl_add_u32 v41, v44, 3, v41
    v_add_u32 v41, s99, v41
    s_waitcnt lgkmcnt(8)
    v_mfma_f32_32x32x16_bf16 v[64:79], v[20:23], v[152:155], v[64:79]
    v_add_u32 v3, 66048, v3
    ds_read_b64_tr_b16 v[36:37], v3 offset:0
    ds_read_b64_tr_b16 v[38:39], v3 offset:512
    ds_read_b128 v[168:171], v82 offset:0
    buffer_store_dwordx4 v[248:251], v0, s[20:23], s83 offen sc1
    ds_read_b64_tr_b16 v[240:241], v41 offset:0
    ds_read_b64_tr_b16 v[242:243], v41 offset:1024
    s_waitcnt lgkmcnt(11)
    v_mfma_f32_32x32x16_bf16 v[64:79], v[24:27], v[156:159], v[64:79]
    v_add_u32 v4, 66048, v4
    ds_read_b64_tr_b16 v[20:21], v4 offset:0
    ds_read_b64_tr_b16 v[22:23], v4 offset:512
    ds_read_b128 v[172:175], v83 offset:0
    s_add_u32 m0, s44, 26656
    s_nop 0
    buffer_load_dwordx4 v86, s[8:11], s41 offen offset:128 lds
    ds_read_b64_tr_b16 v[244:245], v41 offset:32
    ds_read_b64_tr_b16 v[246:247], v41 offset:1056
    s_waitcnt lgkmcnt(13)
    v_mfma_f32_32x32x16_bf16 v[48:63], v[28:31], v[160:163], v[48:63]
    ds_read_b64_tr_b16 v[24:25], v1 offset:32
    ds_read_b64_tr_b16 v[26:27], v1 offset:544
    s_waitcnt lgkmcnt(12)
    v_mfma_f32_32x32x16_bf16 v[48:63], v[32:35], v[164:167], v[48:63]
    ds_read_b64_tr_b16 v[28:29], v2 offset:32
    ds_read_b64_tr_b16 v[30:31], v2 offset:544
    s_add_u32 m0, s44, 134144
    s_add_u32 s40, s40, 128
    s_cmp_eq_u32 s40, 1280
    s_cselect_b32 s40, 0, s40
    buffer_load_dwordx4 v84, s[4:7], s40 offen lds
    s_waitcnt lgkmcnt(11)
    v_mfma_f32_32x32x16_bf16 v[48:63], v[36:39], v[168:171], v[48:63]
    ds_read_b64_tr_b16 v[32:33], v3 offset:32
    ds_read_b64_tr_b16 v[34:35], v3 offset:544
    s_waitcnt lgkmcnt(11)
    buffer_store_dwordx4 v[240:243], v0, s[20:23], s88 offen sc1
    s_waitcnt lgkmcnt(8)
    v_mfma_f32_32x32x16_bf16 v[48:63], v[20:23], v[172:175], v[48:63]
    ds_read_b64_tr_b16 v[36:37], v4 offset:32
    ds_read_b64_tr_b16 v[38:39], v4 offset:544
    s_add_u32 m0, s44, 35072
    s_add_u32 s41, s41, 245760
    s_cmp_eq_u32 s41, 2457600
    s_cselect_b32 s41, 0, s41
    buffer_load_dwordx4 v86, s[8:11], s41 offen lds
    s_waitcnt lgkmcnt(6)
    v_mfma_f32_32x32x16_bf16 v[64:79], v[24:27], v[160:163], v[64:79]
    v_smfmac_f32_16x16x64_bf16 v[12:15], v[8:11], v[20:27], v16
    s_waitcnt vmcnt(9)
    s_waitcnt vmcnt(8)
    s_barrier
    v_add_u32 v1, -66048, v1
    ds_read_b64_tr_b16 v[20:21], v1 offset:0
    ds_read_b64_tr_b16 v[22:23], v1 offset:512
    ds_read_b128 v[176:179], v80 offset:16512
    s_waitcnt lgkmcnt(7)
    v_mfma_f32_32x32x16_bf16 v[64:79], v[28:31], v[164:167], v[64:79]
    v_add_u32 v2, -66048, v2
    ds_read_b64_tr_b16 v[24:25], v2 offset:0
    ds_read_b64_tr_b16 v[26:27], v2 offset:512
    ds_read_b128 v[180:183], v81 offset:16512
    s_add_u32 m0, s44, 142336
    s_nop 0
    buffer_load_dwordx4 v85, s[4:7], s40 offen lds
    s_waitcnt lgkmcnt(8)
    v_mfma_f32_32x32x16_bf16 v[64:79], v[32:35], v[168:171], v[64:79]
    v_add_u32 v3, -66048, v3
    ds_read_b64_tr_b16 v[28:29], v3 offset:0
    ds_read_b64_tr_b16 v[30:31], v3 offset:512
    ds_read_b128 v[184:187], v82 offset:16512
    buffer_store_dwordx4 v[244:247], v0, s[20:23], s89 offen sc1
    s_add_u32 m0, s44, 43168
    s_nop 0
    buffer_load_dwordx4 v86, s[8:11], s41 offen offset:128 lds
    s_waitcnt lgkmcnt(9)
    v_mfma_f32_32x32x16_bf16 v[64:79], v[36:39], v[172:175], v[64:79]
    v_add_u32 v4, -66048, v4
    ds_read_b64_tr_b16 v[32:33], v4 offset:0
    ds_read_b64_tr_b16 v[34:35], v4 offset:512
    ds_read_b128 v[188:191], v83 offset:16512
    s_add_u32 m0, s44, 84608
    s_add_u32 s40, s40, 128
    s_cmp_eq_u32 s40, 1280
    s_cselect_b32 s40, 0, s40
    buffer_load_dwordx4 v84, s[4:7], s40 offen lds
    s_waitcnt lgkmcnt(9)
    v_mfma_f32_32x32x16_bf16 v[48:63], v[20:23], v[176:179], v[48:63]
    ds_read_b64_tr_b16 v[36:37], v1 offset:32
    ds_read_b64_tr_b16 v[38:39], v1 offset:544
    s_and_b32 s47, s39, 3
    s_lshl1_add_u32 s48, s47, s37
    s_lshl_b32 s49, s48, 12
    s_add_u32 s32, s55, s49
    s_lshl2_add_u32 s49, s47, s37
    s_lshl_b32 s49, s49, 10
    s_add_u32 s33, s55, s49
    s_add_u32 s33, s33, 32768
    s_waitcnt lgkmcnt(8)
    v_mfma_f32_32x32x16_bf16 v[48:63], v[24:27], v[180:183], v[48:63]
    ds_read_b64_tr_b16 v[20:21], v2 offset:32
    ds_read_b64_tr_b16 v[22:23], v2 offset:544
    s_add_u32 m0, s44, 51584
    s_add_u32 s41, s41, 245760
    s_cmp_eq_u32 s41, 2457600
    s_cselect_b32 s41, 0, s41
    buffer_load_dwordx4 v86, s[8:11], s41 offen lds
    s_lshl4_add_u32 s47, s38, s39
    s_lshl_b32 s47, s47, 7
    s_add_u32 s34, s47, 21815296
    s_lshl3_add_u32 s35, s44, 21815296
    s_cmp_lg_u32 s3, 0
    s_cmov_b32 s34, 2147483632
    s_waitcnt lgkmcnt(7)
    v_mfma_f32_32x32x16_bf16 v[48:63], v[28:31], v[184:187], v[48:63]
    ds_read_b64_tr_b16 v[24:25], v3 offset:32
    ds_read_b64_tr_b16 v[26:27], v3 offset:544
    s_waitcnt lgkmcnt(6)
    v_mfma_f32_32x32x16_bf16 v[48:63], v[32:35], v[188:191], v[48:63]
    ds_read_b64_tr_b16 v[28:29], v4 offset:32
    ds_read_b64_tr_b16 v[30:31], v4 offset:544
    s_add_u32 m0, s44, 92800
    s_nop 0
    buffer_load_dwordx4 v85, s[4:7], s40 offen lds
    s_waitcnt lgkmcnt(6)
    v_mfma_f32_32x32x16_bf16 v[64:79], v[36:39], v[176:179], v[64:79]
    v_smfmac_f32_16x16x64_bf16 v[12:15], v[8:11], v[32:39], v16
    s_waitcnt vmcnt(11)
    s_waitcnt vmcnt(9)
    s_barrier
    ds_read_b64_tr_b16 v[32:33], v1 offset:16512
    ds_read_b64_tr_b16 v[34:35], v1 offset:17024
    ds_read_b128 v[192:195], v80 offset:33024
    s_waitcnt lgkmcnt(7)
    v_mfma_f32_32x32x16_bf16 v[64:79], v[20:23], v[180:183], v[64:79]
    ds_read_b64_tr_b16 v[36:37], v2 offset:16512
    ds_read_b64_tr_b16 v[38:39], v2 offset:17024
    ds_read_b128 v[196:199], v81 offset:33024
    s_add_u32 m0, s44, 59680
    s_nop 0
    buffer_load_dwordx4 v86, s[8:11], s41 offen offset:128 lds
    s_waitcnt lgkmcnt(8)
    v_mfma_f32_32x32x16_bf16 v[64:79], v[24:27], v[184:187], v[64:79]
    ds_read_b64_tr_b16 v[20:21], v3 offset:16512
    ds_read_b64_tr_b16 v[22:23], v3 offset:17024
    ds_read_b128 v[200:203], v82 offset:33024
    s_add_u32 m0, s44, 101120
    s_add_u32 s40, s40, 128
    s_cmp_eq_u32 s40, 1280
    s_cselect_b32 s40, 0, s40
    buffer_load_dwordx4 v84, s[4:7], s40 offen lds
    s_waitcnt lgkmcnt(9)
    v_mfma_f32_32x32x16_bf16 v[64:79], v[28:31], v[188:191], v[64:79]
    ds_read_b64_tr_b16 v[24:25], v4 offset:16512
    ds_read_b64_tr_b16 v[26:27], v4 offset:17024
    ds_read_b128 v[204:207], v83 offset:33024
    s_add_u32 m0, s44, 68096
    s_add_u32 s41, s41, 245760
    s_cmp_eq_u32 s41, 2457600
    s_cselect_b32 s41, 0, s41
    buffer_load_dwordx4 v86, s[8:11], s41 offen lds
    s_waitcnt lgkmcnt(9)
    v_mfma_f32_32x32x16_bf16 v[48:63], v[32:35], v[192:195], v[48:63]
    ds_read_b64_tr_b16 v[28:29], v1 offset:16544
    ds_read_b64_tr_b16 v[30:31], v1 offset:17056
    s_waitcnt lgkmcnt(8)
    v_mfma_f32_32x32x16_bf16 v[48:63], v[36:39], v[196:199], v[48:63]
    ds_read_b64_tr_b16 v[32:33], v2 offset:16544
    ds_read_b64_tr_b16 v[34:35], v2 offset:17056
    s_add_u32 m0, s44, 109312
    s_nop 0
    buffer_load_dwordx4 v85, s[4:7], s40 offen lds
    s_waitcnt lgkmcnt(7)
    v_mfma_f32_32x32x16_bf16 v[48:63], v[20:23], v[200:203], v[48:63]
    ds_read_b64_tr_b16 v[36:37], v3 offset:16544
    ds_read_b64_tr_b16 v[38:39], v3 offset:17056
    s_waitcnt lgkmcnt(6)
    v_mfma_f32_32x32x16_bf16 v[48:63], v[24:27], v[204:207], v[48:63]
    ds_read_b64_tr_b16 v[20:21], v4 offset:16544
    ds_read_b64_tr_b16 v[22:23], v4 offset:17056
    s_add_u32 m0, s44, 76192
    s_nop 0
    buffer_load_dwordx4 v86, s[8:11], s41 offen offset:128 lds
    buffer_load_dwordx2 v[88:89], v90, s[20:23], 0 offen sc1
    s_waitcnt lgkmcnt(6)
    v_mfma_f32_32x32x16_bf16 v[64:79], v[28:31], v[192:195], v[64:79]
    v_smfmac_f32_16x16x64_bf16 v[12:15], v[8:11], v[24:31], v16
    s_waitcnt vmcnt(11)
    s_waitcnt vmcnt(9)
    s_barrier
    ds_read_b64_tr_b16 v[24:25], v1 offset:33024
    ds_read_b64_tr_b16 v[26:27], v1 offset:33536
    ds_read_b128 v[208:211], v80 offset:49536
    s_add_u32 m0, s44, 117632
    s_nop 0
    buffer_load_dwordx4 v5, s[12:15], s42 offen lds
    s_waitcnt lgkmcnt(7)
    v_mfma_f32_32x32x16_bf16 v[64:79], v[32:35], v[196:199], v[64:79]
    ds_read_b64_tr_b16 v[28:29], v1 offset:33056
    ds_read_b64_tr_b16 v[30:31], v1 offset:33568
    ds_read_b128 v[212:215], v81 offset:49536
    s_add_u32 m0, s44, 125856
    s_nop 0
    buffer_load_dwordx4 v5, s[16:19], s42 offen lds
    s_waitcnt lgkmcnt(8)
    v_mfma_f32_32x32x16_bf16 v[64:79], v[36:39], v[200:203], v[64:79]
    ds_read_b64_tr_b16 v[32:33], v2 offset:33024
    ds_read_b64_tr_b16 v[34:35], v2 offset:33536
    ds_read_b128 v[216:219], v82 offset:49536
    s_add_u32 m0, s44, 2048
    s_add_u32 s42, s42, 196608
    s_cmp_eq_u32 s42, 1966080
    s_cselect_b32 s42, 0, s42
    buffer_load_dwordx4 v5, s[12:15], s42 offen lds
    s_waitcnt lgkmcnt(9)
    v_mfma_f32_32x32x16_bf16 v[64:79], v[20:23], v[204:207], v[64:79]
    ds_read_b64_tr_b16 v[36:37], v3 offset:33024
    ds_read_b64_tr_b16 v[38:39], v3 offset:33536
    ds_read_b128 v[220:223], v83 offset:49536
    s_add_u32 m0, s44, 10272
    s_nop 0
    buffer_load_dwordx4 v5, s[16:19], s42 offen lds
    s_waitcnt lgkmcnt(9)
    v_mfma_f32_32x32x16_bf16 v[48:63], v[24:27], v[208:211], v[48:63]
    ds_read_b64_tr_b16 v[20:21], v4 offset:33024
    ds_read_b64_tr_b16 v[22:23], v4 offset:33536
    s_waitcnt lgkmcnt(9)
    v_mfma_f32_32x32x16_bf16 v[64:79], v[28:31], v[208:211], v[64:79]
    v_smfmac_f32_16x16x64_bf16 v[12:15], v[8:11], v[24:31], v16
    ds_read_b64_tr_b16 v[24:25], v2 offset:33056
    ds_read_b64_tr_b16 v[26:27], v2 offset:33568
    s_waitcnt lgkmcnt(8)
    v_mfma_f32_32x32x16_bf16 v[48:63], v[32:35], v[212:215], v[48:63]
    ds_read_b64_tr_b16 v[28:29], v3 offset:33056
    ds_read_b64_tr_b16 v[30:31], v3 offset:33568
    s_waitcnt lgkmcnt(7)
    v_mfma_f32_32x32x16_bf16 v[48:63], v[36:39], v[216:219], v[48:63]
    ds_read_b64_tr_b16 v[32:33], v4 offset:33056
    ds_read_b64_tr_b16 v[34:35], v4 offset:33568
    s_waitcnt lgkmcnt(6)
    v_mfma_f32_32x32x16_bf16 v[48:63], v[20:23], v[220:223], v[48:63]
    s_waitcnt vmcnt(10)
    s_waitcnt vmcnt(9)
    s_barrier
    ds_read_b64_tr_b16 v[36:37], v1 offset:49536
    ds_read_b64_tr_b16 v[38:39], v1 offset:50048
    ds_read_b128 v[224:227], v80 offset:0
    s_mov_b64 s[8:9], s[20:21]
    s_cmp_eq_u32 s39, 15
    s_cselect_b32 s10, 0, 7866368
    s_waitcnt lgkmcnt(7)
    v_mfma_f32_32x32x16_bf16 v[64:79], v[24:27], v[212:215], v[64:79]
    ds_read_b64_tr_b16 v[20:21], v2 offset:49536
    ds_read_b64_tr_b16 v[22:23], v2 offset:50048
    ds_read_b128 v[228:231], v81 offset:0
    s_waitcnt lgkmcnt(8)
    v_mfma_f32_32x32x16_bf16 v[64:79], v[28:31], v[216:219], v[64:79]
    ds_read_b64_tr_b16 v[24:25], v3 offset:49536
    ds_read_b64_tr_b16 v[26:27], v3 offset:50048
    ds_read_b128 v[232:235], v82 offset:0
    s_waitcnt lgkmcnt(9)
    v_mfma_f32_32x32x16_bf16 v[64:79], v[32:35], v[220:223], v[64:79]
    ds_read_b64_tr_b16 v[28:29], v4 offset:49536
    ds_read_b64_tr_b16 v[30:31], v4 offset:50048
    ds_read_b128 v[236:239], v83 offset:0
    s_waitcnt lgkmcnt(9)
    v_mfma_f32_32x32x16_bf16 v[48:63], v[36:39], v[224:227], v[48:63]
    ds_read_b64_tr_b16 v[32:33], v1 offset:49568
    ds_read_b64_tr_b16 v[34:35], v1 offset:50080
    s_and_b32 s47, s39, 3
    s_lshl1_add_u32 s48, s47, s37
    s_lshl_b32 s48, s48, 8
    s_add_u32 s40, s55, s48
    s_add_u32 s40, s40, 65536
    s_lshr_b32 s48, s47, 1
    s_lshl1_add_u32 s48, s37, s48
    s_and_b32 s47, s47, 1
    s_lshl2_add_u32 s48, s48, s47
    s_lshl_b32 s48, s48, 10
    s_add_u32 s95, s55, s48
    s_add_u32 s95, s95, 49152
    s_waitcnt lgkmcnt(8)
    v_mfma_f32_32x32x16_bf16 v[48:63], v[20:23], v[228:231], v[48:63]
    ds_read_b64_tr_b16 v[36:37], v2 offset:49568
    ds_read_b64_tr_b16 v[38:39], v2 offset:50080
    s_mov_b64 s[24:25], s[70:71]
    s_mov_b32 s26, 2621440
    s_mov_b32 s27, 0x00020000
    s_lshr_b32 s47, s46, 1
    s_lshr_b32 s48, s39, 2
    s_lshl2_add_u32 s47, s47, s48
    s_waitcnt lgkmcnt(7)
    v_mfma_f32_32x32x16_bf16 v[48:63], v[24:27], v[232:235], v[48:63]
    ds_read_b64_tr_b16 v[20:21], v3 offset:49568
    ds_read_b64_tr_b16 v[22:23], v3 offset:50080
    s_and_b32 s48, s36, 1
    s_lshl1_add_u32 s47, s47, s48
    s_and_b32 s48, s39, 3
    s_lshl2_add_u32 s47, s47, s48
    s_lshl1_add_u32 s47, s47, s37
    s_lshl_b32 s47, s47, 7
    s_add_u32 s28, s47, 21880832
    s_waitcnt lgkmcnt(6)
    v_mfma_f32_32x32x16_bf16 v[48:63], v[28:31], v[236:239], v[48:63]
    ds_read_b64_tr_b16 v[24:25], v4 offset:49568
    ds_read_b64_tr_b16 v[26:27], v4 offset:50080
    s_add_u32 m0, s44, 134144
    s_add_u32 s42, s42, 196608
    s_cmp_eq_u32 s42, 1966080
    s_cselect_b32 s42, 0, s42
    buffer_load_dwordx4 v5, s[12:15], s42 offen lds
    s_and_b32 s47, s2, 1
    s_bfe_u32 s48, s2, 0x10001
    s_lshl1_add_u32 s53, s47, s48
    s_bfe_u32 s48, s2, 0x30003
    s_lshl3_add_u32 s53, s53, s48
    s_waitcnt lgkmcnt(6)
    v_mfma_f32_32x32x16_bf16 v[64:79], v[32:35], v[224:227], v[64:79]
    v_smfmac_f32_16x16x64_bf16 v[12:15], v[8:11], v[28:35], v16
    s_waitcnt vmcnt(7)
    s_waitcnt vmcnt(6)
    s_barrier
    v_add_u32 v1, 66048, v1
    ds_read_b64_tr_b16 v[28:29], v1 offset:0
    ds_read_b64_tr_b16 v[30:31], v1 offset:512
    ds_read_b128 v[240:243], v80 offset:16512
    v_mov_b32 v42, s45
    s_mov_b64 exec, 0xff
    buffer_store_dwordx4 v[40:43], v0, s[20:23], s34 offen sc1
    s_mov_b64 exec, -1
    s_add_u32 s34, s34, 32768
    s_bfe_u32 s54, s2, 0x10002
    s_lshr_b32 s48, s2, 6
    s_lshl2_add_u32 s54, s54, s48
    s_lshl2_add_u32 s47, s53, s36
    s_lshl_b32 s47, s47, 11
    s_add_u32 s30, s47, 21880832
    s_waitcnt lgkmcnt(7)
    v_mfma_f32_32x32x16_bf16 v[64:79], v[36:39], v[228:231], v[64:79]
    ds_read_b64_tr_b16 v[32:33], v1 offset:32
    ds_read_b64_tr_b16 v[34:35], v1 offset:544
    ds_read_b128 v[244:247], v81 offset:16512
    s_add_u32 m0, s44, 142368
    s_nop 0
    buffer_load_dwordx4 v5, s[16:19], s42 offen lds
    s_mul_i32 s47, s53, 278784
    s_mul_i32 s48, s36, 69632
    s_add_u32 s55, s47, s48
    s_add_u32 s55, s55, 7866368
    s_waitcnt lgkmcnt(8)
    v_mfma_f32_32x32x16_bf16 v[64:79], v[20:23], v[232:235], v[64:79]
    v_add_u32 v2, 66048, v2
    ds_read_b64_tr_b16 v[36:37], v2 offset:0
    ds_read_b64_tr_b16 v[38:39], v2 offset:512
    ds_read_b128 v[248:251], v82 offset:16512
    s_mul_i32 s47, s54, 348288
    s_mul_i32 s48, s36, 87040
    s_add_u32 s31, s47, s48
    s_add_u32 s31, s31, 16787456
    s_waitcnt lgkmcnt(9)
    v_mfma_f32_32x32x16_bf16 v[64:79], v[24:27], v[236:239], v[64:79]
    s_waitcnt lgkmcnt(4)
    v_smfmac_f32_16x16x64_bf16 v[12:15], v[8:11], v[28:35], v16
    v_add_u32 v3, 66048, v3
    ds_read_b64_tr_b16 v[20:21], v3 offset:0
    ds_read_b64_tr_b16 v[22:23], v3 offset:512
    ds_read_b128 v[252:255], v83 offset:16512
    s_add_u32 m0, s44, 84608
    s_add_u32 s42, s42, 196608
    s_cmp_eq_u32 s42, 1966080
    s_cselect_b32 s42, 0, s42
    buffer_load_dwordx4 v5, s[12:15], s42 offen lds
    v_mfma_f32_32x32x16_bf16 v[48:63], v[28:31], v[240:243], v[48:63]
    v_add_u32 v4, 66048, v4
    ds_read_b64_tr_b16 v[24:25], v4 offset:0
    ds_read_b64_tr_b16 v[26:27], v4 offset:512
    s_lshl_b32 s0, s37, 10
    v_add_f32 v12, v12, v13
    v_add_u32 v17, s0, v0
    v_lshl_add_u32 v13, s36, 2, v17
    ds_write_b32 v13, v12 offset:0
    v_mfma_f32_32x32x16_bf16 v[64:79], v[32:35], v[240:243], v[64:79]
    ds_read_b64_tr_b16 v[28:29], v2 offset:32
    ds_read_b64_tr_b16 v[30:31], v2 offset:544
    s_add_u32 m0, s44, 92832
    s_nop 0
    buffer_load_dwordx4 v5, s[16:19], s42 offen lds
    s_waitcnt vmcnt(9)
    v_cmp_ne_u32 vcc, s45, v89
    s_cbranch_vccnz Lpl_4_e
Lpd_3:
    v_and_b32 v89, 0xffff0000, v88
    v_and_b32 v88, 0xffff, v88
    v_rcp_f32 v40, v89
    v_lshl_or_b32 v88, v88, 16, v88
    s_cmp_lt_u32 s39, 5
    s_cselect_b32 s0, 0x3ea52b5c, 1.0
    v_cndmask_b32 v6, v88, 0, s[90:91]
    v_cndmask_b32 v7, 0, v88, s[90:91]
    v_mul_f32 v41, s0, v40
    v_mul_f32 v40, v40, v40
    s_waitcnt lgkmcnt(9)
    v_mfma_f32_32x32x16_bf16 v[48:63], v[36:39], v[244:247], v[48:63]
    ds_read_b64_tr_b16 v[32:33], v3 offset:32
    ds_read_b64_tr_b16 v[34:35], v3 offset:544
    s_waitcnt lgkmcnt(8)
    v_mfma_f32_32x32x16_bf16 v[48:63], v[20:23], v[248:251], v[48:63]
    ds_read_b64_tr_b16 v[36:37], v4 offset:32
    ds_read_b64_tr_b16 v[38:39], v4 offset:544
    s_add_u32 m0, s44, 35072
    s_add_u32 s42, s42, 196608
    s_cmp_eq_u32 s42, 1966080
    s_cselect_b32 s42, 0, s42
    buffer_load_dwordx4 v5, s[12:15], s42 offen lds
    s_waitcnt lgkmcnt(7)
    v_mfma_f32_32x32x16_bf16 v[48:63], v[24:27], v[252:255], v[48:63]
    s_waitcnt vmcnt(8)
    s_waitcnt lgkmcnt(6)
    s_barrier
    ds_read_b128 v[12:15], v17 offset:0
    ds_read_b64_tr_b16 v[20:21], v1 offset:49536
    ds_read_b64_tr_b16 v[22:23], v1 offset:50048
    s_waitcnt lgkmcnt(7)
    v_mfma_f32_32x32x16_bf16 v[64:79], v[28:31], v[244:247], v[64:79]
    ds_read_b64_tr_b16 v[24:25], v2 offset:49536
    ds_read_b64_tr_b16 v[26:27], v2 offset:50048
    s_waitcnt lgkmcnt(4)
    v_add_f32 v12, v12, v13
    v_add_f32 v14, v14, v15
    v_mov_b32 v17, 0
    v_add_f32 v12, v12, v14
    v_mov_b32 v18, 0
    v_cvt_pk_bf16_f32 v13, v12, v12
    v_and_b32 v13, 0xffff0000, v13
    v_sub_f32 v12, v12, v13
    v_cvt_pk_bf16_f32 v16, v13, v12
    v_cvt_pk_bf16_f32 v19, v13, v12
    v_mov_b32 v12, 0
    v_mov_b32 v13, 0
    s_add_u32 m0, s44, 43296
    s_nop 0
    buffer_load_dwordx4 v5, s[16:19], s42 offen lds
    v_mfma_f32_32x32x16_bf16 v[64:79], v[32:35], v[248:251], v[64:79]
    ds_read_b64_tr_b16 v[28:29], v3 offset:49536
    ds_read_b64_tr_b16 v[30:31], v3 offset:50048
    v_mfma_f32_32x32x8_bf16 v[48:63], v[16:17], v[6:7], v[48:63]
    v_mfma_f32_32x32x16_bf16 v[64:79], v[36:39], v[252:255], v[64:79]
    ds_read_b64_tr_b16 v[32:33], v4 offset:49536
    ds_read_b64_tr_b16 v[34:35], v4 offset:50048
    v_mfma_f32_32x32x8_bf16 v[64:79], v[18:19], v[6:7], v[64:79]
    s_nop 7
    v_mul_f32 v48, v41, v48
    v_mul_f32 v49, v41, v49
    v_mul_f32 v50, v41, v50
    v_mul_f32 v51, v41, v51
    s_waitcnt lgkmcnt(6)
    v_mfma_f32_32x32x16_bf16 v[80:95], v[20:23], v[96:99], 0
    ds_read_b64_tr_b16 v[36:37], v1 offset:49568
    ds_read_b64_tr_b16 v[38:39], v1 offset:50080
    s_add_u32 s47, s92, 0
    s_mul_i32 s48, s47, 205
    s_add_u32 s49, s48, 205
    s_lshr_b32 s48, s48, 10
    s_lshr_b32 s49, s49, 10
    v_cvt_pk_bf16_f32 v48, v48, v49
    v_cvt_pk_bf16_f32 v49, v50, v51
    s_sub_u32 s49, s49, s48
    s_mul_i32 s49, s49, 489088
    s_mul_i32 s48, s48, 489088
    v_lshrrev_b32 v44, 9, v0
    s_lshl_b32 s47, s47, 9
    s_add_u32 s47, s47, s93
    s_add_u32 s47, s47, s48
    v_mul_f32 v52, v41, v52
    v_mul_f32 v53, v41, v53
    v_mul_f32 v54, v41, v54
    v_mul_f32 v55, v41, v55
    s_waitcnt lgkmcnt(6)
    v_mfma_f32_32x32x16_bf16 v[80:95], v[24:27], v[100:103], v[80:95]
    v_bfe_i32 v16, v0, 4, 1
    v_and_b32 v16, 0xaaaa, v16
    v_or_b32 v16, 0x4444, v16
    ds_read_b64_tr_b16 v[20:21], v2 offset:49568
    ds_read_b64_tr_b16 v[22:23], v2 offset:50080
    v_cvt_pk_bf16_f32 v50, v52, v53
    v_cvt_pk_bf16_f32 v51, v54, v55
    v_mad_u32_u24 v44, v44, s49, v0
    v_permlane32_swap_b32 v48, v50
    v_permlane32_swap_b32 v49, v51
    buffer_store_dwordx4 v[48:51], v44, s[8:11], s47 offen sc1
    v_mul_f32 v56, v41, v56
    v_mul_f32 v57, v41, v57
    v_mul_f32 v58, v41, v58
    v_mul_f32 v59, v41, v59
    s_waitcnt lgkmcnt(6)
    v_mfma_f32_32x32x16_bf16 v[80:95], v[28:31], v[104:107], v[80:95]
    ds_read_b64_tr_b16 v[24:25], v3 offset:49568
    ds_read_b64_tr_b16 v[26:27], v3 offset:50080
    s_add_u32 s47, s92, 8
    s_mul_i32 s48, s47, 205
    s_add_u32 s49, s48, 205
    s_lshr_b32 s48, s48, 10
    s_lshr_b32 s49, s49, 10
    v_cvt_pk_bf16_f32 v52, v56, v57
    v_cvt_pk_bf16_f32 v53, v58, v59
    s_sub_u32 s49, s49, s48
    s_mul_i32 s49, s49, 489088
    s_mul_i32 s48, s48, 489088
    v_lshrrev_b32 v44, 9, v0
    s_lshl_b32 s47, s47, 9
    s_add_u32 s47, s47, s93
    s_add_u32 s47, s47, s48
    v_mul_f32 v60, v41, v60
    v_mul_f32 v61, v41, v61
    v_mul_f32 v62, v41, v62
    v_mul_f32 v63, v41, v63
    s_waitcnt lgkmcnt(6)
    v_mfma_f32_32x32x16_bf16 v[80:95], v[32:35], v[108:111], v[80:95]
    ds_read_b64_tr_b16 v[28:29], v4 offset:49568
    ds_read_b64_tr_b16 v[30:31], v4 offset:50080
    v_cvt_pk_bf16_f32 v54, v60, v61
    v_cvt_pk_bf16_f32 v55, v62, v63
    v_mad_u32_u24 v44, v44, s49, v0
    v_permlane32_swap_b32 v52, v54
    v_permlane32_swap_b32 v53, v55
    buffer_store_dwordx4 v[52:55], v44, s[8:11], s47 offen sc1
    s_waitcnt lgkmcnt(6)
    s_nop 0
    v_mfma_f32_32x32x16_bf16 v[48:63], v[36:39], v[96:99], 0
    v_smfmac_f32_16x16x64_bf16 v[12:15], v[8:11], v[32:39], v16
    s_waitcnt vmcnt(9)
    s_barrier
    v_add_u32 v1, -66048, v1
    ds_read_b64_tr_b16 v[32:33], v1 offset:0
    ds_read_b64_tr_b16 v[34:35], v1 offset:512
    v_mul_f32 v64, v41, v64
    v_mul_f32 v65, v41, v65
    v_mul_f32 v66, v41, v66
    v_mul_f32 v67, v41, v67
    s_waitcnt lgkmcnt(6)
    v_mfma_f32_32x32x16_bf16 v[48:63], v[20:23], v[100:103], v[48:63]
    v_add_u32 v2, -66048, v2
    ds_read_b64_tr_b16 v[36:37], v2 offset:0
    ds_read_b64_tr_b16 v[38:39], v2 offset:512
    s_add_u32 s47, s92, 2
    s_mul_i32 s48, s47, 205
    s_add_u32 s49, s48, 205
    s_lshr_b32 s48, s48, 10
    s_lshr_b32 s49, s49, 10
    v_cvt_pk_bf16_f32 v64, v64, v65
    v_cvt_pk_bf16_f32 v65, v66, v67
    s_sub_u32 s49, s49, s48
    s_mul_i32 s49, s49, 489088
    s_mul_i32 s48, s48, 489088
    v_lshrrev_b32 v44, 9, v0
    s_lshl_b32 s47, s47, 9
    s_add_u32 s47, s47, s93
    s_add_u32 s47, s47, s48
    s_waitcnt lgkmcnt(6)
    v_mfma_f32_32x32x16_bf16 v[48:63], v[24:27], v[104:107], v[48:63]
    v_add_u32 v3, -66048, v3
    ds_read_b64_tr_b16 v[20:21], v3 offset:0
    ds_read_b64_tr_b16 v[22:23], v3 offset:512
    v_mul_f32 v68, v41, v68
    v_mul_f32 v69, v41, v69
    v_mul_f32 v70, v41, v70
    v_mul_f32 v71, v41, v71
    s_waitcnt lgkmcnt(6)
    v_mfma_f32_32x32x16_bf16 v[48:63], v[28:31], v[108:111], v[48:63]
    v_add_u32 v4, -66048, v4
    ds_read_b64_tr_b16 v[24:25], v4 offset:0
    ds_read_b64_tr_b16 v[26:27], v4 offset:512
    v_cvt_pk_bf16_f32 v66, v68, v69
    v_cvt_pk_bf16_f32 v67, v70, v71
    v_mad_u32_u24 v44, v44, s49, v0
    v_permlane32_swap_b32 v64, v66
    v_permlane32_swap_b32 v65, v67
    buffer_store_dwordx4 v[64:67], v44, s[8:11], s47 offen sc1
    s_waitcnt lgkmcnt(6)
    v_mfma_f32_32x32x16_bf16 v[80:95], v[32:35], v[112:115], v[80:95]
    ds_read_b64_tr_b16 v[28:29], v1 offset:32
    ds_read_b64_tr_b16 v[30:31], v1 offset:544
    v_mul_f32 v72, v41, v72
    v_mul_f32 v73, v41, v73
    v_mul_f32 v74, v41, v74
    v_mul_f32 v75, v41, v75
    s_waitcnt lgkmcnt(6)
    v_mfma_f32_32x32x16_bf16 v[80:95], v[36:39], v[116:119], v[80:95]
    ds_read_b64_tr_b16 v[32:33], v2 offset:32
    ds_read_b64_tr_b16 v[34:35], v2 offset:544
    s_add_u32 s47, s92, 10
    s_mul_i32 s48, s47, 205
    s_add_u32 s49, s48, 205
    s_lshr_b32 s48, s48, 10
    s_lshr_b32 s49, s49, 10
    v_cvt_pk_bf16_f32 v68, v72, v73
    v_cvt_pk_bf16_f32 v69, v74, v75
    s_sub_u32 s49, s49, s48
    s_mul_i32 s49, s49, 489088
    s_mul_i32 s48, s48, 489088
    v_lshrrev_b32 v44, 9, v0
    s_lshl_b32 s47, s47, 9
    s_add_u32 s47, s47, s93
    s_add_u32 s47, s47, s48
    s_waitcnt lgkmcnt(6)
    v_mfma_f32_32x32x16_bf16 v[80:95], v[20:23], v[120:123], v[80:95]
    ds_read_b64_tr_b16 v[36:37], v3 offset:32
    ds_read_b64_tr_b16 v[38:39], v3 offset:544
    v_mul_f32 v76, v41, v76
    v_mul_f32 v77, v41, v77
    v_mul_f32 v78, v41, v78
    v_mul_f32 v79, v41, v79
    s_waitcnt lgkmcnt(6)
    v_mfma_f32_32x32x16_bf16 v[80:95], v[24:27], v[124:127], v[80:95]
    ds_read_b64_tr_b16 v[20:21], v4 offset:32
    ds_read_b64_tr_b16 v[22:23], v4 offset:544
    v_cvt_pk_bf16_f32 v70, v76, v77
    v_cvt_pk_bf16_f32 v71, v78, v79
    v_mad_u32_u24 v44, v44, s49, v0
    v_permlane32_swap_b32 v68, v70
    v_permlane32_swap_b32 v69, v71
    buffer_store_dwordx4 v[68:71], v44, s[8:11], s47 offen sc1
    s_waitcnt lgkmcnt(6)
    v_mfma_f32_32x32x16_bf16 v[48:63], v[28:31], v[112:115], v[48:63]
    v_smfmac_f32_16x16x64_bf16 v[12:15], v[8:11], v[24:31], v16
    s_waitcnt vmcnt(8)
    s_barrier
    v_add_u32 v1, 82560, v1
    ds_read_b64_tr_b16 v[24:25], v1 offset:49536
    ds_read_b64_tr_b16 v[26:27], v1 offset:50048
    s_waitcnt lgkmcnt(6)
    v_mfma_f32_32x32x16_bf16 v[48:63], v[32:35], v[116:119], v[48:63]
    ds_read_b64_tr_b16 v[28:29], v1 offset:49568
    ds_read_b64_tr_b16 v[30:31], v1 offset:50080
    s_add_u32 m0, s44, 117632
    s_add_u32 s42, s42, 196608
    s_cmp_eq_u32 s42, 1966080
    s_cselect_b32 s42, 0, s42
    buffer_load_dwordx4 v5, s[12:15], s42 offen lds
    s_waitcnt lgkmcnt(6)
    v_mfma_f32_32x32x16_bf16 v[48:63], v[36:39], v[120:123], v[48:63]
    v_add_u32 v2, 82560, v2
    ds_read_b64_tr_b16 v[32:33], v2 offset:49536
    ds_read_b64_tr_b16 v[34:35], v2 offset:50048
    s_waitcnt lgkmcnt(6)
    v_mfma_f32_32x32x16_bf16 v[48:63], v[20:23], v[124:127], v[48:63]
    v_add_u32 v3, 82560, v3
    ds_read_b64_tr_b16 v[36:37], v3 offset:49536
    ds_read_b64_tr_b16 v[38:39], v3 offset:50048
    s_add_u32 m0, s44, 125856
    s_nop 0
    buffer_load_dwordx4 v5, s[16:19], s42 offen lds
    v_mov_b32 v44, -1
    v_mov_b32 v45, -1
    v_mov_b32 v46, -1
    v_mov_b32 v47, -1
    s_cmp_lg_u32 s37, 0
    s_cbranch_scc1 L_A
    s_waitcnt lgkmcnt(6)
    v_mfma_f32_32x32x16_bf16 v[80:95], v[24:27], v[128:131], v[80:95]
    v_add_u32 v4, 82560, v4
    ds_read_b64_tr_b16 v[20:21], v4 offset:49536
    ds_read_b64_tr_b16 v[22:23], v4 offset:50048
    buffer_store_dwordx4 v[44:47], v0, s[20:23], s95 offen offset:0 sc1
    s_waitcnt lgkmcnt(6)
    v_mfma_f32_32x32x16_bf16 v[48:63], v[28:31], v[128:131], v[48:63]
    v_smfmac_f32_16x16x64_bf16 v[12:15], v[8:11], v[24:31], v16
    ds_read_b64_tr_b16 v[24:25], v2 offset:49568
    ds_read_b64_tr_b16 v[26:27], v2 offset:50080
    s_add_u32 m0, s44, 68096
    s_add_u32 s42, s42, 196608
    s_cmp_eq_u32 s42, 1966080
    s_cselect_b32 s42, 0, s42
    buffer_load_dwordx4 v5, s[12:15], s42 offen lds
    s_waitcnt lgkmcnt(6)
    v_mfma_f32_32x32x16_bf16 v[80:95], v[32:35], v[132:135], v[80:95]
    ds_read_b64_tr_b16 v[28:29], v3 offset:49568
    ds_read_b64_tr_b16 v[30:31], v3 offset:50080
    s_waitcnt lgkmcnt(6)
    v_mfma_f32_32x32x16_bf16 v[80:95], v[36:39], v[136:139], v[80:95]
    ds_read_b64_tr_b16 v[32:33], v4 offset:49568
    ds_read_b64_tr_b16 v[34:35], v4 offset:50080
    s_add_u32 m0, s44, 76320
    s_nop 0
    buffer_load_dwordx4 v5, s[16:19], s42 offen lds
    s_mov_b64 exec, 0xffff
    buffer_store_dwordx4 v[44:47], v0, s[20:23], s40 offen offset:0 sc1
    s_mov_b64 exec, -1
    s_waitcnt lgkmcnt(6)
    v_mfma_f32_32x32x16_bf16 v[80:95], v[20:23], v[140:143], v[80:95]
    s_waitcnt vmcnt(12)
    s_barrier
    ds_read_b64_tr_b16 v[36:37], v1 offset:0
    ds_read_b64_tr_b16 v[38:39], v1 offset:512
    v_lshlrev_b32 v73, 3, v0
    buffer_load_dword v72, v73, s[20:23], s35 offen offset:8 sc1
    s_waitcnt lgkmcnt(6)
    v_mfma_f32_32x32x16_bf16 v[48:63], v[24:27], v[132:135], v[48:63]
    ds_read_b64_tr_b16 v[20:21], v2 offset:0
    ds_read_b64_tr_b16 v[22:23], v2 offset:512
    s_add_u32 m0, s44, 51584
    s_add_u32 s42, s42, 196608
    s_cmp_eq_u32 s42, 1966080
    s_cselect_b32 s42, 0, s42
    buffer_load_dwordx4 v5, s[12:15], s42 offen lds
    s_waitcnt lgkmcnt(6)
    v_mfma_f32_32x32x16_bf16 v[48:63], v[28:31], v[136:139], v[48:63]
    ds_read_b64_tr_b16 v[24:25], v3 offset:0
    ds_read_b64_tr_b16 v[26:27], v3 offset:512
    buffer_store_dwordx4 v[44:47], v0, s[20:23], s33 offen offset:0 sc1
    s_waitcnt lgkmcnt(6)
    v_mfma_f32_32x32x16_bf16 v[48:63], v[32:35], v[140:143], v[48:63]
    ds_read_b64_tr_b16 v[28:29], v4 offset:0
    ds_read_b64_tr_b16 v[30:31], v4 offset:512
    s_add_u32 m0, s44, 59808
    s_nop 0
    buffer_load_dwordx4 v5, s[16:19], s42 offen lds
    s_waitcnt lgkmcnt(6)
    v_mfma_f32_32x32x16_bf16 v[80:95], v[36:39], v[144:147], v[80:95]
    ds_read_b64_tr_b16 v[32:33], v1 offset:32
    ds_read_b64_tr_b16 v[34:35], v1 offset:544
    s_waitcnt lgkmcnt(6)
    v_mfma_f32_32x32x16_bf16 v[80:95], v[20:23], v[148:151], v[80:95]
    ds_read_b64_tr_b16 v[36:37], v2 offset:32
    ds_read_b64_tr_b16 v[38:39], v2 offset:544
    s_waitcnt lgkmcnt(6)
    v_mfma_f32_32x32x16_bf16 v[80:95], v[24:27], v[152:155], v[80:95]
    ds_read_b64_tr_b16 v[20:21], v3 offset:32
    ds_read_b64_tr_b16 v[22:23], v3 offset:544
    s_waitcnt lgkmcnt(6)
    v_mfma_f32_32x32x16_bf16 v[80:95], v[28:31], v[156:159], v[80:95]
    ds_read_b64_tr_b16 v[24:25], v4 offset:32
    ds_read_b64_tr_b16 v[26:27], v4 offset:544
    s_waitcnt lgkmcnt(6)
    v_mfma_f32_32x32x16_bf16 v[48:63], v[32:35], v[144:147], v[48:63]
    v_smfmac_f32_16x16x64_bf16 v[12:15], v[8:11], v[28:35], v16
    s_waitcnt vmcnt(10)
    s_barrier
    v_add_u32 v1, -49536, v1
    ds_read_b64_tr_b16 v[28:29], v1 offset:0
    ds_read_b64_tr_b16 v[30:31], v1 offset:512
    v_mov_b32 v42, s45
    s_mov_b64 exec, 0xff
    buffer_store_dwordx4 v[40:43], v0, s[20:23], s34 offen sc1
    s_mov_b64 exec, -1
    s_add_u32 s34, s34, 32768
    s_waitcnt lgkmcnt(6)
    v_mfma_f32_32x32x16_bf16 v[48:63], v[36:39], v[148:151], v[48:63]
    v_add_u32 v2, -49536, v2
    ds_read_b64_tr_b16 v[32:33], v2 offset:0
    ds_read_b64_tr_b16 v[34:35], v2 offset:512
    s_add_u32 m0, s44, 18560
    s_add_u32 s42, s42, 196608
    s_cmp_eq_u32 s42, 1966080
    s_cselect_b32 s42, 0, s42
    buffer_load_dwordx4 v5, s[12:15], s42 offen lds
    s_waitcnt lgkmcnt(6)
    v_mfma_f32_32x32x16_bf16 v[48:63], v[20:23], v[152:155], v[48:63]
    v_add_u32 v3, -49536, v3
    ds_read_b64_tr_b16 v[36:37], v3 offset:0
    ds_read_b64_tr_b16 v[38:39], v3 offset:512
    s_waitcnt lgkmcnt(6)
    v_mfma_f32_32x32x16_bf16 v[48:63], v[24:27], v[156:159], v[48:63]
    v_add_u32 v4, -49536, v4
    ds_read_b64_tr_b16 v[20:21], v4 offset:0
    ds_read_b64_tr_b16 v[22:23], v4 offset:512
    s_add_u32 m0, s44, 26784
    s_nop 0
    buffer_load_dwordx4 v5, s[16:19], s42 offen lds
    s_waitcnt lgkmcnt(6)
    v_mfma_f32_32x32x16_bf16 v[80:95], v[28:31], v[160:163], v[80:95]
    ds_read_b64_tr_b16 v[24:25], v1 offset:32
    ds_read_b64_tr_b16 v[26:27], v1 offset:544
    s_waitcnt lgkmcnt(6)
    v_mfma_f32_32x32x16_bf16 v[80:95], v[32:35], v[164:167], v[80:95]
    ds_read_b64_tr_b16 v[28:29], v2 offset:32
    ds_read_b64_tr_b16 v[30:31], v2 offset:544
    s_add_u32 m0, s44, 2048
    s_add_u32 s42, s42, 196608
    s_cmp_eq_u32 s42, 1966080
    s_cselect_b32 s42, 0, s42
    buffer_load_dwordx4 v5, s[12:15], s42 offen lds
    s_waitcnt lgkmcnt(6)
    v_mfma_f32_32x32x16_bf16 v[80:95], v[36:39], v[168:171], v[80:95]
    ds_read_b64_tr_b16 v[32:33], v3 offset:32
    ds_read_b64_tr_b16 v[34:35], v3 offset:544
    s_waitcnt lgkmcnt(6)
    v_mfma_f32_32x32x16_bf16 v[80:95], v[20:23], v[172:175], v[80:95]
    ds_read_b64_tr_b16 v[36:37], v4 offset:32
    ds_read_b64_tr_b16 v[38:39], v4 offset:544
    s_add_u32 m0, s44, 10272
    s_nop 0
    buffer_load_dwordx4 v5, s[16:19], s42 offen lds
    s_waitcnt lgkmcnt(6)
    v_mfma_f32_32x32x16_bf16 v[48:63], v[24:27], v[160:163], v[48:63]
    v_smfmac_f32_16x16x64_bf16 v[12:15], v[8:11], v[20:27], v16
    s_waitcnt vmcnt(13)
    s_waitcnt vmcnt(8)
    v_cmp_ne_u32 s[0:1], s45, v72
    s_cmp_lg_u64 s[0:1], 0
    s_cbranch_scc1 Lfl_6_e
Lfd_5:
    s_barrier
    v_add_u32 v1, 33024, v1
    ds_read_b64_tr_b16 v[20:21], v1 offset:49536
    ds_read_b64_tr_b16 v[22:23], v1 offset:50048
    s_waitcnt lgkmcnt(6)
    v_mfma_f32_32x32x16_bf16 v[48:63], v[28:31], v[164:167], v[48:63]
    v_add_u32 v2, 33024, v2
    ds_read_b64_tr_b16 v[24:25], v2 offset:49536
    ds_read_b64_tr_b16 v[26:27], v2 offset:50048
    s_add_u32 s42, s42, 196608
    s_cmp_eq_u32 s42, 1966080
    s_cselect_b32 s42, 0, s42
    s_mul_i32 s0, s39, 123136
    s_lshl1_add_u32 s0, s44, s0
    s_lshr_b32 s42, s42, 4
    s_add_u32 s0, s0, 19582976
    v_add_u32 v5, s0, v0
    s_add_u32 m0, s44, 84608
    s_nop 0
    buffer_load_dwordx4 v5, s[20:23], s42 offen sc1 lds
    s_waitcnt lgkmcnt(6)
    v_mfma_f32_32x32x16_bf16 v[48:63], v[32:35], v[168:171], v[48:63]
    v_add_u32 v3, 33024, v3
    ds_read_b64_tr_b16 v[28:29], v3 offset:49536
    ds_read_b64_tr_b16 v[30:31], v3 offset:50048
    s_waitcnt lgkmcnt(6)
    v_mfma_f32_32x32x16_bf16 v[48:63], v[36:39], v[172:175], v[48:63]
    v_add_u32 v4, 33024, v4
    ds_read_b64_tr_b16 v[32:33], v4 offset:49536
    ds_read_b64_tr_b16 v[34:35], v4 offset:50048
    s_add_u32 m0, s44, 91808
    s_nop 0
    buffer_load_dwordx4 v5, s[20:23], s42 offen offset:1024 sc1 lds
    s_waitcnt lgkmcnt(6)
    v_mfma_f32_32x32x16_bf16 v[80:95], v[20:23], v[176:179], v[80:95]
    ds_read_b64_tr_b16 v[36:37], v1 offset:49568
    ds_read_b64_tr_b16 v[38:39], v1 offset:50080
    s_waitcnt lgkmcnt(6)
    v_mfma_f32_32x32x16_bf16 v[80:95], v[24:27], v[180:183], v[80:95]
    ds_read_b64_tr_b16 v[20:21], v2 offset:49568
    ds_read_b64_tr_b16 v[22:23], v2 offset:50080
    s_waitcnt lgkmcnt(6)
    v_mfma_f32_32x32x16_bf16 v[80:95], v[28:31], v[184:187], v[80:95]
    ds_read_b64_tr_b16 v[24:25], v3 offset:49568
    ds_read_b64_tr_b16 v[26:27], v3 offset:50080
    s_waitcnt lgkmcnt(6)
    v_mfma_f32_32x32x16_bf16 v[80:95], v[32:35], v[188:191], v[80:95]
    ds_read_b64_tr_b16 v[28:29], v4 offset:49568
    ds_read_b64_tr_b16 v[30:31], v4 offset:50080
    s_waitcnt lgkmcnt(6)
    v_mfma_f32_32x32x16_bf16 v[48:63], v[36:39], v[176:179], v[48:63]
    v_smfmac_f32_16x16x64_bf16 v[12:15], v[8:11], v[32:39], v16
    s_barrier
    ds_read_b64_tr_b16 v[32:33], v1 offset:0
    ds_read_b64_tr_b16 v[34:35], v1 offset:512
    s_waitcnt lgkmcnt(6)
    v_mfma_f32_32x32x16_bf16 v[48:63], v[20:23], v[180:183], v[48:63]
    ds_read_b64_tr_b16 v[36:37], v2 offset:0
    ds_read_b64_tr_b16 v[38:39], v2 offset:512
    s_add_u32 m0, s44, 35072
    s_add_u32 s42, s42, 24576
    s_cmp_eq_u32 s42, 122880
    s_cselect_b32 s42, 0, s42
    buffer_load_dwordx4 v5, s[20:23], s42 offen sc1 lds
    s_waitcnt lgkmcnt(6)
    v_mfma_f32_32x32x16_bf16 v[48:63], v[24:27], v[184:187], v[48:63]
    ds_read_b64_tr_b16 v[20:21], v3 offset:0
    ds_read_b64_tr_b16 v[22:23], v3 offset:512
    s_waitcnt lgkmcnt(6)
    v_mfma_f32_32x32x16_bf16 v[48:63], v[28:31], v[188:191], v[48:63]
    ds_read_b64_tr_b16 v[24:25], v4 offset:0
    ds_read_b64_tr_b16 v[26:27], v4 offset:512
    s_add_u32 m0, s44, 42272
    s_nop 0
    buffer_load_dwordx4 v5, s[20:23], s42 offen offset:1024 sc1 lds
    s_waitcnt lgkmcnt(6)
    v_mfma_f32_32x32x16_bf16 v[80:95], v[32:35], v[192:195], v[80:95]
    ds_read_b64_tr_b16 v[28:29], v1 offset:32
    ds_read_b64_tr_b16 v[30:31], v1 offset:544
    s_waitcnt lgkmcnt(6)
    v_mfma_f32_32x32x16_bf16 v[80:95], v[36:39], v[196:199], v[80:95]
    ds_read_b64_tr_b16 v[32:33], v2 offset:32
    ds_read_b64_tr_b16 v[34:35], v2 offset:544
    s_waitcnt lgkmcnt(6)
    v_mfma_f32_32x32x16_bf16 v[80:95], v[20:23], v[200:203], v[80:95]
    ds_read_b64_tr_b16 v[36:37], v3 offset:32
    ds_read_b64_tr_b16 v[38:39], v3 offset:544
    v_bfe_u32 v75, v0, 5, 1
    s_mul_i32 s0, s39, 40
    v_mul_u32_u24 v75, 640, v75
    v_bfe_u32 v74, v0, 4, 1
    s_add_u32 s0, s0, 640
    v_mad_u32_u24 v75, v74, 39, v75
    v_bfe_u32 v74, v0, 6, 2
    v_add_u32 v75, s0, v75
    s_sub_i32 s1, s38, 2
    v_min_u32 v74, 2, v74
    v_and_b32 v75, 0xffffff80, v75
    v_add_u32 v74, s1, v74
    s_mov_b32 s35, 21848064
    v_max_i32 v74, 0, v74
    v_lshl_add_u32 v75, v74, 11, v75
    buffer_load_dword v74, v75, s[20:23], s35 offen offset:8 sc1
    s_waitcnt lgkmcnt(6)
    v_mfma_f32_32x32x16_bf16 v[80:95], v[24:27], v[204:207], v[80:95]
    ds_read_b64_tr_b16 v[20:21], v4 offset:32
    ds_read_b64_tr_b16 v[22:23], v4 offset:544
    s_waitcnt lgkmcnt(6)
    v_mfma_f32_32x32x16_bf16 v[48:63], v[28:31], v[192:195], v[48:63]
    v_smfmac_f32_16x16x64_bf16 v[12:15], v[8:11], v[24:31], v16
    s_waitcnt vmcnt(10)
    s_barrier
    v_add_u32 v1, -66048, v1
    ds_read_b64_tr_b16 v[24:25], v1 offset:49536
    ds_read_b64_tr_b16 v[26:27], v1 offset:50048
    v_lshrrev_b32 v44, 4, v0
    v_min_u32 v44, 11, v44
    s_lshl_b32 s47, s38, 2
    s_sub_i32 s47, 8, s47
    v_cmp_gt_i32 vcc, s47, v44
    v_mov_b32 v46, 0x3f800000
    v_mov_b32 v47, 0x3f80fe80
    v_cndmask_b32 v46, v46, v47, vcc
    s_waitcnt lgkmcnt(6)
    v_mfma_f32_32x32x16_bf16 v[48:63], v[32:35], v[196:199], v[48:63]
    ds_read_b64_tr_b16 v[28:29], v1 offset:49568
    ds_read_b64_tr_b16 v[30:31], v1 offset:50080
    v_mov_b32 v47, 0
    v_mul_u32_u24 v44, 5152, v44
    v_add_u32 v44, 107136, v44
    ds_write_b64 v44, v[46:47]
    s_waitcnt lgkmcnt(7)
    v_mfma_f32_32x32x16_bf16 v[48:63], v[36:39], v[200:203], v[48:63]
    v_add_u32 v2, -66048, v2
    ds_read_b64_tr_b16 v[32:33], v2 offset:49536
    ds_read_b64_tr_b16 v[34:35], v2 offset:50048
    v_lshrrev_b32 v45, 2, v0
    v_add_u32 v45, 101120, v45
    ds_write_b32 v45, v47
    s_waitcnt lgkmcnt(8)
    v_mfma_f32_32x32x16_bf16 v[48:63], v[20:23], v[204:207], v[48:63]
    v_add_u32 v3, -66048, v3
    ds_read_b64_tr_b16 v[36:37], v3 offset:49536
    ds_read_b64_tr_b16 v[38:39], v3 offset:50048
    v_mov_b32 v46, 0x3f803f80
    v_mov_b32 v47, 0x3f803f80
    ds_write_b64 v44, v[46:47] offset:8
    s_waitcnt lgkmcnt(9)
    v_mfma_f32_32x32x16_bf16 v[80:95], v[24:27], v[208:211], v[80:95]
    v_add_u32 v4, -66048, v4
    ds_read_b64_tr_b16 v[20:21], v4 offset:49536
    ds_read_b64_tr_b16 v[22:23], v4 offset:50048
    s_waitcnt lgkmcnt(9)
    v_mfma_f32_32x32x16_bf16 v[48:63], v[28:31], v[208:211], v[48:63]
    v_smfmac_f32_16x16x64_bf16 v[12:15], v[8:11], v[24:31], v16
    ds_read_b64_tr_b16 v[24:25], v2 offset:49568
    ds_read_b64_tr_b16 v[26:27], v2 offset:50080
    s_waitcnt vmcnt(0)
    v_cmp_ne_u32 s[0:1], s45, v74
    s_cmp_lg_u64 s[0:1], 0
    s_cbranch_scc1 Lfl_8_e
Lfd_7:
    s_waitcnt lgkmcnt(8)
    v_mfma_f32_32x32x16_bf16 v[80:95], v[32:35], v[212:215], v[80:95]
    ds_read_b64_tr_b16 v[28:29], v3 offset:49568
    ds_read_b64_tr_b16 v[30:31], v3 offset:50080
    v_lshrrev_b32 v41, 3, v0
    s_mul_i32 s99, s36, 5152
    v_and_b32 v41, 64, v41
    s_mul_i32 s97, s39, 491648
    v_xor_b32 v41, v41, v0
    s_add_u32 s97, s97, 2560
    s_sub_i32 s0, s46, 0
    s_max_i32 s0, s0, 0
    s_mul_i32 s0, s0, 7680
    s_add_u32 s98, s0, s97
    s_add_u32 m0, s99, 143232
    s_nop 0
    buffer_load_dwordx4 v41, s[20:23], s98 offen sc1 lds
    s_waitcnt lgkmcnt(7)
    v_mfma_f32_32x32x16_bf16 v[80:95], v[36:39], v[216:219], v[80:95]
    ds_read_b64_tr_b16 v[32:33], v4 offset:49568
    ds_read_b64_tr_b16 v[34:35], v4 offset:50080
    s_waitcnt lgkmcnt(6)
    v_mfma_f32_32x32x16_bf16 v[80:95], v[20:23], v[220:223], v[80:95]
    s_barrier
    ds_read_b64_tr_b16 v[36:37], v1 offset:16512
    ds_read_b64_tr_b16 v[38:39], v1 offset:17024
    s_add_u32 m0, s99, 143232
    s_nop 0
    buffer_load_dwordx4 v41, s[20:23], s98 offen offset:1024 sc1 lds
    s_waitcnt lgkmcnt(6)
    v_mfma_f32_32x32x16_bf16 v[48:63], v[24:27], v[212:215], v[48:63]
    ds_read_b64_tr_b16 v[20:21], v2 offset:16512
    ds_read_b64_tr_b16 v[22:23], v2 offset:17024
    s_add_u32 m0, s44, 68096
    s_add_u32 s42, s42, 24576
    s_cmp_eq_u32 s42, 122880
    s_cselect_b32 s42, 0, s42
    buffer_load_dwordx4 v5, s[20:23], s42 offen sc1 lds
    s_waitcnt lgkmcnt(6)
    v_mfma_f32_32x32x16_bf16 v[48:63], v[28:31], v[216:219], v[48:63]
    ds_read_b64_tr_b16 v[24:25], v3 offset:16512
    ds_read_b64_tr_b16 v[26:27], v3 offset:17024
    s_add_u32 m0, s99, 143232
    s_nop 0
    buffer_load_dwordx4 v41, s[20:23], s98 offen offset:2048 sc1 lds
    s_waitcnt lgkmcnt(6)
    v_mfma_f32_32x32x16_bf16 v[48:63], v[32:35], v[220:223], v[48:63]
    ds_read_b64_tr_b16 v[28:29], v4 offset:16512
    ds_read_b64_tr_b16 v[30:31], v4 offset:17024
    s_add_u32 m0, s44, 75296
    s_nop 0
    buffer_load_dwordx4 v5, s[20:23], s42 offen offset:1024 sc1 lds
    s_waitcnt lgkmcnt(6)
    v_mfma_f32_32x32x16_bf16 v[80:95], v[36:39], v[224:227], v[80:95]
    ds_read_b64_tr_b16 v[32:33], v1 offset:16544
    ds_read_b64_tr_b16 v[34:35], v1 offset:17056
    s_add_u32 m0, s99, 143232
    s_nop 0
    buffer_load_dwordx4 v41, s[20:23], s98 offen offset:3072 sc1 lds
    s_waitcnt lgkmcnt(6)
    v_mfma_f32_32x32x16_bf16 v[80:95], v[20:23], v[228:231], v[80:95]
    ds_read_b64_tr_b16 v[36:37], v2 offset:16544
    ds_read_b64_tr_b16 v[38:39], v2 offset:17056
    s_waitcnt lgkmcnt(6)
    v_mfma_f32_32x32x16_bf16 v[80:95], v[24:27], v[232:235], v[80:95]
    ds_read_b64_tr_b16 v[20:21], v3 offset:16544
    ds_read_b64_tr_b16 v[22:23], v3 offset:17056
    s_add_u32 m0, s99, 147328
    s_add_u32 s98, s98, 4096
    buffer_load_dwordx4 v41, s[20:23], s98 offen sc1 lds
    s_waitcnt lgkmcnt(6)
    v_mfma_f32_32x32x16_bf16 v[80:95], v[28:31], v[236:239], v[80:95]
    ds_read_b64_tr_b16 v[24:25], v4 offset:16544
    ds_read_b64_tr_b16 v[26:27], v4 offset:17056
    s_waitcnt lgkmcnt(6)
    v_mfma_f32_32x32x16_bf16 v[48:63], v[32:35], v[224:227], v[48:63]
    v_smfmac_f32_16x16x64_bf16 v[12:15], v[8:11], v[28:35], v16
    s_barrier
    ds_read_b64_tr_b16 v[28:29], v1 offset:0
    ds_read_b64_tr_b16 v[30:31], v1 offset:512
    s_sub_i32 s0, s46, 4
    s_max_i32 s0, s0, 0
    s_mul_i32 s0, s0, 7680
    s_add_u32 s98, s0, s97
    s_add_u32 m0, s99, 122624
    s_nop 0
    buffer_load_dwordx4 v41, s[20:23], s98 offen sc1 lds
    s_waitcnt lgkmcnt(6)
    v_mfma_f32_32x32x16_bf16 v[48:63], v[36:39], v[228:231], v[48:63]
    ds_read_b64_tr_b16 v[32:33], v1 offset:32
    ds_read_b64_tr_b16 v[34:35], v1 offset:544
    s_add_u32 m0, s44, 51584
    s_add_u32 s42, s42, 24576
    s_cmp_eq_u32 s42, 122880
    s_cselect_b32 s42, 0, s42
    buffer_load_dwordx4 v5, s[20:23], s42 offen sc1 lds
    s_waitcnt lgkmcnt(6)
    v_mfma_f32_32x32x16_bf16 v[48:63], v[20:23], v[232:235], v[48:63]
    ds_read_b64_tr_b16 v[36:37], v2 offset:0
    ds_read_b64_tr_b16 v[38:39], v2 offset:512
    s_add_u32 m0, s99, 122624
    s_nop 0
    buffer_load_dwordx4 v41, s[20:23], s98 offen offset:1024 sc1 lds
    s_waitcnt lgkmcnt(6)
    v_mfma_f32_32x32x16_bf16 v[48:63], v[24:27], v[236:239], v[48:63]
    s_waitcnt lgkmcnt(2)
    v_smfmac_f32_16x16x64_bf16 v[12:15], v[8:11], v[28:35], v16
    ds_read_b64_tr_b16 v[20:21], v3 offset:0
    ds_read_b64_tr_b16 v[22:23], v3 offset:512
    s_add_u32 m0, s44, 58784
    s_nop 0
    buffer_load_dwordx4 v5, s[20:23], s42 offen offset:1024 sc1 lds
    v_mfma_f32_32x32x16_bf16 v[80:95], v[28:31], v[240:243], v[80:95]
    ds_read_b64_tr_b16 v[24:25], v4 offset:0
    ds_read_b64_tr_b16 v[26:27], v4 offset:512
    s_lshl_b32 s0, s37, 10
    v_add_f32 v12, v12, v13
    v_add_u32 v17, s0, v0
    v_lshl_add_u32 v13, s36, 2, v17
    ds_write_b32 v13, v12 offset:0
    s_add_u32 m0, s99, 122624
    s_nop 0
    buffer_load_dwordx4 v41, s[20:23], s98 offen offset:2048 sc1 lds
    v_mfma_f32_32x32x16_bf16 v[48:63], v[32:35], v[240:243], v[48:63]
    ds_read_b64_tr_b16 v[28:29], v2 offset:32
    ds_read_b64_tr_b16 v[30:31], v2 offset:544
    s_waitcnt lgkmcnt(7)
    v_mfma_f32_32x32x16_bf16 v[80:95], v[36:39], v[244:247], v[80:95]
    ds_read_b64_tr_b16 v[32:33], v3 offset:32
    ds_read_b64_tr_b16 v[34:35], v3 offset:544
    s_add_u32 m0, s99, 122624
    s_nop 0
    buffer_load_dwordx4 v41, s[20:23], s98 offen offset:3072 sc1 lds
    s_waitcnt lgkmcnt(7)
    v_mfma_f32_32x32x16_bf16 v[80:95], v[20:23], v[248:251], v[80:95]
    ds_read_b64_tr_b16 v[36:37], v4 offset:32
    ds_read_b64_tr_b16 v[38:39], v4 offset:544
    s_waitcnt lgkmcnt(7)
    v_mfma_f32_32x32x16_bf16 v[80:95], v[24:27], v[252:255], v[80:95]
    s_waitcnt lgkmcnt(6)
    s_barrier
    ds_read_b128 v[12:15], v17 offset:0
    v_add_u32 v2, 33024, v2
    ds_read_b64_tr_b16 v[20:21], v2 offset:49536
    ds_read_b64_tr_b16 v[22:23], v2 offset:50048
    s_add_u32 m0, s44, 18560
    s_add_u32 s42, s42, 24576
    s_cmp_eq_u32 s42, 122880
    s_cselect_b32 s42, 0, s42
    buffer_load_dwordx4 v5, s[20:23], s42 offen sc1 lds
    s_add_u32 m0, s99, 126720
    s_add_u32 s98, s98, 4096
    buffer_load_dwordx4 v41, s[20:23], s98 offen sc1 lds
    s_waitcnt lgkmcnt(7)
    v_mfma_f32_32x32x16_bf16 v[48:63], v[28:31], v[244:247], v[48:63]
    v_add_u32 v3, 33024, v3
    ds_read_b64_tr_b16 v[24:25], v3 offset:49536
    ds_read_b64_tr_b16 v[26:27], v3 offset:50048
    s_waitcnt lgkmcnt(4)
    v_add_f32 v12, v12, v13
    v_add_f32 v14, v14, v15
    v_mov_b32 v17, 0
    v_add_f32 v12, v12, v14
    v_mov_b32 v18, 0
    v_cvt_pk_bf16_f32 v13, v12, v12
    v_and_b32 v13, 0xffff0000, v13
    v_sub_f32 v12, v12, v13
    v_cvt_pk_bf16_f32 v16, v13, v12
    v_cvt_pk_bf16_f32 v19, v13, v12
    v_mov_b32 v12, 0
    v_mov_b32 v13, 0
    s_add_u32 m0, s44, 25760
    s_nop 0
    buffer_load_dwordx4 v5, s[20:23], s42 offen offset:1024 sc1 lds
    v_mfma_f32_32x32x16_bf16 v[48:63], v[32:35], v[248:251], v[48:63]
    v_add_u32 v4, 33024, v4
    ds_read_b64_tr_b16 v[28:29], v4 offset:49536
    ds_read_b64_tr_b16 v[30:31], v4 offset:50048
    v_mfma_f32_32x32x8_bf16 v[80:95], v[16:17], v[6:7], v[80:95]
    s_add_u32 m0, s44, 22656
    s_add_u32 s96, s42, 8192
    buffer_load_dwordx4 v5, s[20:23], s96 offen sc1 lds
    s_sub_i32 s0, s46, 8
    s_max_i32 s0, s0, 0
    s_mul_i32 s0, s0, 7680
    s_add_u32 s98, s0, s97
    s_add_u32 m0, s99, 102016
    s_nop 0
    buffer_load_dwordx4 v41, s[20:23], s98 offen sc1 lds
    v_mfma_f32_32x32x16_bf16 v[48:63], v[36:39], v[252:255], v[48:63]
    ds_read_b64_tr_b16 v[32:33], v2 offset:49568
    ds_read_b64_tr_b16 v[34:35], v2 offset:50080
    v_mfma_f32_32x32x8_bf16 v[48:63], v[18:19], v[6:7], v[48:63]
    s_add_u32 m0, s44, 29856
    s_nop 0
    buffer_load_dwordx4 v5, s[20:23], s96 offen offset:1024 sc1 lds
    s_setprio 3
    v_xor_b32 v44, 64, v1
    v_xor_b32 v45, 64, v2
    v_xor_b32 v46, 64, v3
    v_xor_b32 v47, 64, v4
    s_waitcnt lgkmcnt(6)
    v_mfma_f32_32x32x16_bf16 v[64:79], v[20:23], v[100:103], 0
    ds_read_b64_tr_b16 v[36:37], v3 offset:49568
    ds_read_b64_tr_b16 v[38:39], v3 offset:50080
    s_add_u32 m0, s99, 102016
    s_nop 0
    buffer_load_dwordx4 v41, s[20:23], s98 offen offset:1024 sc1 lds
    v_max_f32 v80, 0, v80
    v_mul_f32 v88, v40, v88
    v_max_f32 v81, 0, v81
    v_mul_f32 v89, v40, v89
    v_mul_f32 v80, v80, v88
    v_mul_f32 v81, v81, v89
    v_cvt_pk_bf16_f32 v80, v80, v81
    s_waitcnt lgkmcnt(6)
    v_mfma_f32_32x32x16_bf16 v[64:79], v[24:27], v[104:107], v[64:79]
    v_bfe_i32 v16, v0, 4, 1
    v_and_b32 v16, 0xaaaa, v16
    v_or_b32 v16, 0x4444, v16
    ds_read_b64_tr_b16 v[20:21], v4 offset:49568
    ds_read_b64_tr_b16 v[22:23], v4 offset:50080
    s_add_u32 m0, s99, 102016
    s_nop 0
    buffer_load_dwordx4 v41, s[20:23], s98 offen offset:2048 sc1 lds
    v_max_f32 v82, 0, v82
    v_mul_f32 v90, v40, v90
    v_max_f32 v83, 0, v83
    v_mul_f32 v91, v40, v91
    v_mul_f32 v82, v82, v90
    v_mul_f32 v83, v83, v91
    v_cvt_pk_bf16_f32 v81, v82, v83
    s_waitcnt lgkmcnt(6)
    v_mfma_f32_32x32x16_bf16 v[64:79], v[28:31], v[108:111], v[64:79]
    v_add_u32 v1, 33024, v1
    ds_read_b64_tr_b16 v[24:25], v1 offset:49536
    ds_read_b64_tr_b16 v[26:27], v1 offset:50048
    s_add_u32 m0, s99, 102016
    s_nop 0
    buffer_load_dwordx4 v41, s[20:23], s98 offen offset:3072 sc1 lds
    v_max_f32 v84, 0, v84
    v_mul_f32 v92, v40, v92
    v_max_f32 v85, 0, v85
    v_mul_f32 v93, v40, v93
    v_mul_f32 v84, v84, v92
    v_mul_f32 v85, v85, v93
    v_cvt_pk_bf16_f32 v82, v84, v85
    s_waitcnt lgkmcnt(6)
    v_mfma_f32_32x32x16_bf16 v[64:79], v[32:35], v[116:119], v[64:79]
    v_add_u32 v44, 33024, v44
    ds_read_b64_tr_b16 v[28:29], v44 offset:49536
    ds_read_b64_tr_b16 v[30:31], v44 offset:50048
    s_add_u32 m0, s99, 106112
    s_add_u32 s98, s98, 4096
    buffer_load_dwordx4 v41, s[20:23], s98 offen sc1 lds
    v_max_f32 v86, 0, v86
    v_mul_f32 v94, v40, v94
    v_max_f32 v87, 0, v87
    v_mul_f32 v95, v40, v95
    v_mul_f32 v86, v86, v94
    v_mul_f32 v87, v87, v95
    v_cvt_pk_bf16_f32 v83, v86, v87
    s_waitcnt lgkmcnt(6)
    v_mfma_f32_32x32x16_bf16 v[64:79], v[36:39], v[120:123], v[64:79]
    ds_read_b64_tr_b16 v[32:33], v1 offset:49568
    ds_read_b64_tr_b16 v[34:35], v1 offset:50080
    buffer_store_dwordx4 v[80:83], v0, s[20:23], s32 offen offset:0 sc1
    v_max_f32 v48, 0, v48
    v_mul_f32 v56, v40, v56
    v_max_f32 v49, 0, v49
    v_mul_f32 v57, v40, v57
    s_waitcnt lgkmcnt(6)
    v_mfma_f32_32x32x16_bf16 v[64:79], v[20:23], v[124:127], v[64:79]
    ds_read_b64_tr_b16 v[36:37], v44 offset:49568
    ds_read_b64_tr_b16 v[38:39], v44 offset:50080
    v_mul_f32 v48, v48, v56
    v_mul_f32 v49, v49, v57
    v_cvt_pk_bf16_f32 v48, v48, v49
    v_max_f32 v50, 0, v50
    v_mul_f32 v58, v40, v58
    v_max_f32 v51, 0, v51
    v_mul_f32 v59, v40, v59
    s_waitcnt lgkmcnt(6)
    v_mfma_f32_32x32x16_bf16 v[64:79], v[24:27], v[96:99], v[64:79]
    ds_read_b64_tr_b16 v[20:21], v45 offset:49536
    ds_read_b64_tr_b16 v[22:23], v45 offset:50048
    v_mul_f32 v50, v50, v58
    v_mul_f32 v51, v51, v59
    v_cvt_pk_bf16_f32 v49, v50, v51
    v_max_f32 v52, 0, v52
    v_mul_f32 v60, v40, v60
    v_max_f32 v53, 0, v53
    v_mul_f32 v61, v40, v61
    s_waitcnt lgkmcnt(6)
    v_mfma_f32_32x32x16_bf16 v[80:95], v[28:31], v[96:99], 0
    v_smfmac_f32_16x16x64_bf16 v[12:15], v[8:11], v[24:31], v16
    ds_read_b64_tr_b16 v[24:25], v46 offset:49536
    ds_read_b64_tr_b16 v[26:27], v46 offset:50048
    v_mul_f32 v52, v52, v60
    v_mul_f32 v53, v53, v61
    v_cvt_pk_bf16_f32 v50, v52, v53
    v_max_f32 v54, 0, v54
    v_mul_f32 v62, v40, v62
    v_max_f32 v55, 0, v55
    v_mul_f32 v63, v40, v63
    s_waitcnt lgkmcnt(6)
    v_mfma_f32_32x32x16_bf16 v[64:79], v[32:35], v[112:115], v[64:79]
    s_waitcnt vmcnt(1)
    s_barrier
    ds_read_b64_tr_b16 v[28:29], v47 offset:49536
    ds_read_b64_tr_b16 v[30:31], v47 offset:50048
    s_add_u32 s99, s31, 32768
    s_add_u32 m0, s44, 2048
    s_nop 0
    buffer_load_dwordx4 v0, s[20:23], s99 offen sc1 lds
    v_mul_f32 v54, v54, v62
    v_mul_f32 v55, v55, v63
    v_cvt_pk_bf16_f32 v51, v54, v55
    buffer_store_dwordx4 v[48:51], v0, s[20:23], s32 offen offset:1024 sc1
    s_waitcnt lgkmcnt(6)
    v_mfma_f32_32x32x16_bf16 v[80:95], v[36:39], v[112:115], v[80:95]
    v_smfmac_f32_16x16x64_bf16 v[12:15], v[8:11], v[32:39], v16
    ds_read_b64_tr_b16 v[32:33], v45 offset:49568
    ds_read_b64_tr_b16 v[34:35], v45 offset:50080
    s_add_u32 m0, s44, 5120
    s_nop 0
    buffer_load_dwordx4 v0, s[20:23], s99 offen offset:1024 sc1 lds
    s_waitcnt lgkmcnt(6)
    v_mfma_f32_32x32x16_bf16 v[80:95], v[20:23], v[100:103], v[80:95]
    ds_read_b64_tr_b16 v[36:37], v46 offset:49568
    ds_read_b64_tr_b16 v[38:39], v46 offset:50080
    s_add_u32 m0, s44, 8192
    s_nop 0
    buffer_load_dwordx4 v0, s[20:23], s99 offen offset:2048 sc1 lds
    s_waitcnt lgkmcnt(6)
    v_mfma_f32_32x32x16_bf16 v[80:95], v[24:27], v[104:107], v[80:95]
    ds_read_b64_tr_b16 v[20:21], v47 offset:49568
    ds_read_b64_tr_b16 v[22:23], v47 offset:50080
    s_add_u32 m0, s44, 11264
    s_nop 0
    buffer_load_dwordx4 v0, s[20:23], s99 offen offset:3072 sc1 lds
    s_waitcnt lgkmcnt(6)
    v_mfma_f32_32x32x16_bf16 v[80:95], v[28:31], v[108:111], v[80:95]
    ds_read_b64_tr_b16 v[24:25], v1 offset:0
    ds_read_b64_tr_b16 v[26:27], v1 offset:512
    s_add_u32 s99, s31, 0
    buffer_load_dwordx4 v[96:99], v0, s[20:23], s99 offen offset:0 sc1
    s_waitcnt lgkmcnt(6)
    v_mfma_f32_32x32x16_bf16 v[80:95], v[32:35], v[116:119], v[80:95]
    ds_read_b64_tr_b16 v[28:29], v44 offset:0
    ds_read_b64_tr_b16 v[30:31], v44 offset:512
    buffer_load_dwordx4 v[112:115], v0, s[20:23], s99 offen offset:1024 sc1
    s_waitcnt lgkmcnt(6)
    v_mfma_f32_32x32x16_bf16 v[80:95], v[36:39], v[120:123], v[80:95]
    ds_read_b64_tr_b16 v[32:33], v1 offset:32
    ds_read_b64_tr_b16 v[34:35], v1 offset:544
    buffer_load_dwordx4 v[100:103], v0, s[20:23], s99 offen offset:2048 sc1
    s_waitcnt lgkmcnt(6)
    v_mfma_f32_32x32x16_bf16 v[80:95], v[20:23], v[124:127], v[80:95]
    ds_read_b64_tr_b16 v[36:37], v44 offset:32
    ds_read_b64_tr_b16 v[38:39], v44 offset:544
    buffer_load_dwordx4 v[104:107], v0, s[20:23], s99 offen offset:3072 sc1
    s_waitcnt lgkmcnt(6)
    v_mfma_f32_32x32x16_bf16 v[64:79], v[24:27], v[128:131], v[64:79]
    ds_read_b64_tr_b16 v[20:21], v2 offset:0
    ds_read_b64_tr_b16 v[22:23], v2 offset:512
    s_add_u32 s99, s31, 4096
    buffer_load_dwordx4 v[108:111], v0, s[20:23], s99 offen offset:0 sc1
    s_waitcnt lgkmcnt(6)
    v_mfma_f32_32x32x16_bf16 v[80:95], v[28:31], v[128:131], v[80:95]
    v_smfmac_f32_16x16x64_bf16 v[12:15], v[8:11], v[24:31], v16
    ds_read_b64_tr_b16 v[24:25], v45 offset:0
    ds_read_b64_tr_b16 v[26:27], v45 offset:512
    buffer_load_dwordx4 v[116:119], v0, s[20:23], s99 offen offset:1024 sc1
    s_waitcnt lgkmcnt(6)
    v_mfma_f32_32x32x16_bf16 v[64:79], v[32:35], v[144:147], v[64:79]
    ds_read_b64_tr_b16 v[28:29], v3 offset:0
    ds_read_b64_tr_b16 v[30:31], v3 offset:512
    buffer_load_dwordx4 v[120:123], v0, s[20:23], s99 offen offset:2048 sc1
    s_waitcnt lgkmcnt(6)
    v_mfma_f32_32x32x16_bf16 v[80:95], v[36:39], v[144:147], v[80:95]
    v_smfmac_f32_16x16x64_bf16 v[12:15], v[8:11], v[32:39], v16
    ds_read_b64_tr_b16 v[32:33], v46 offset:0
    ds_read_b64_tr_b16 v[34:35], v46 offset:512
    buffer_load_dwordx4 v[124:127], v0, s[20:23], s99 offen offset:3072 sc1
    s_waitcnt lgkmcnt(6)
    v_mfma_f32_32x32x16_bf16 v[64:79], v[20:23], v[132:135], v[64:79]
    ds_read_b64_tr_b16 v[36:37], v4 offset:0
    ds_read_b64_tr_b16 v[38:39], v4 offset:512
    s_add_u32 s99, s31, 8192
    buffer_load_dwordx4 v[128:131], v0, s[20:23], s99 offen offset:0 sc1
    s_waitcnt lgkmcnt(6)
    v_mfma_f32_32x32x16_bf16 v[80:95], v[24:27], v[132:135], v[80:95]
    ds_read_b64_tr_b16 v[20:21], v47 offset:0
    ds_read_b64_tr_b16 v[22:23], v47 offset:512
    buffer_load_dwordx4 v[144:147], v0, s[20:23], s99 offen offset:1024 sc1
    s_waitcnt lgkmcnt(6)
    v_mfma_f32_32x32x16_bf16 v[64:79], v[28:31], v[136:139], v[64:79]
    ds_read_b64_tr_b16 v[24:25], v2 offset:32
    ds_read_b64_tr_b16 v[26:27], v2 offset:544
    s_lshl2_add_u32 s0, s36, 101152
    s_mov_b64 exec, 1
    v_mov_b32 v41, s0
    ds_write_b32 v41, v41
    s_mov_b64 exec, -1
    s_waitcnt vmcnt(13)
    v_mov_b32 v42, s45
    s_mov_b64 exec, 0xff
    buffer_store_dwordx4 v[40:43], v0, s[20:23], s28 offen sc1
    s_mov_b64 exec, -1
    buffer_load_dwordx4 v[132:135], v0, s[20:23], s99 offen offset:2048 sc1
    s_waitcnt lgkmcnt(7)
    v_mfma_f32_32x32x16_bf16 v[80:95], v[32:35], v[136:139], v[80:95]
    ds_read_b64_tr_b16 v[28:29], v45 offset:32
    ds_read_b64_tr_b16 v[30:31], v45 offset:544
    buffer_load_dwordx4 v[136:139], v0, s[20:23], s99 offen offset:3072 sc1
    s_waitcnt lgkmcnt(7)
    v_mfma_f32_32x32x16_bf16 v[64:79], v[36:39], v[140:143], v[64:79]
    ds_read_b64_tr_b16 v[32:33], v3 offset:32
    ds_read_b64_tr_b16 v[34:35], v3 offset:544
    s_waitcnt lgkmcnt(7)
    v_mfma_f32_32x32x16_bf16 v[80:95], v[20:23], v[140:143], v[80:95]
    ds_read_b64_tr_b16 v[36:37], v46 offset:32
    ds_read_b64_tr_b16 v[38:39], v46 offset:544
    s_add_u32 s99, s31, 12288
    buffer_load_dwordx4 v[140:143], v0, s[20:23], s99 offen offset:0 sc1
    s_waitcnt lgkmcnt(7)
    v_mfma_f32_32x32x16_bf16 v[64:79], v[24:27], v[148:151], v[64:79]
    ds_read_b64_tr_b16 v[20:21], v4 offset:32
    ds_read_b64_tr_b16 v[22:23], v4 offset:544
    s_waitcnt lgkmcnt(6)
    v_mfma_f32_32x32x16_bf16 v[80:95], v[28:31], v[148:151], v[80:95]
    ds_read_b64_tr_b16 v[24:25], v47 offset:32
    ds_read_b64_tr_b16 v[26:27], v47 offset:544
    v_mov_b32 v5, 101152
    ds_read_b128 v[56:59], v5
    buffer_load_dwordx4 v[148:151], v0, s[20:23], s99 offen offset:1024 sc1
    s_waitcnt lgkmcnt(7)
    v_mfma_f32_32x32x16_bf16 v[64:79], v[32:35], v[152:155], v[64:79]
    ds_read_b64_tr_b16 v[28:29], v1 offset:33024
    ds_read_b64_tr_b16 v[30:31], v1 offset:33536
    s_waitcnt lgkmcnt(7)
    v_mfma_f32_32x32x16_bf16 v[80:95], v[36:39], v[152:155], v[80:95]
    ds_read_b64_tr_b16 v[32:33], v44 offset:33024
    ds_read_b64_tr_b16 v[34:35], v44 offset:33536
    buffer_load_dwordx4 v[152:155], v0, s[20:23], s99 offen offset:2048 sc1
    s_waitcnt lgkmcnt(7)
    v_mfma_f32_32x32x16_bf16 v[64:79], v[20:23], v[156:159], v[64:79]
    ds_read_b64_tr_b16 v[36:37], v2 offset:33024
    ds_read_b64_tr_b16 v[38:39], v2 offset:33536
    s_waitcnt lgkmcnt(7)
    v_mfma_f32_32x32x16_bf16 v[80:95], v[24:27], v[156:159], v[80:95]
    ds_read_b64_tr_b16 v[20:21], v1 offset:33056
    ds_read_b64_tr_b16 v[22:23], v1 offset:33568
    s_waitcnt lgkmcnt(8)
    v_min3_u32 v56, v56, v57, v58
    v_min_u32 v56, v56, v59
    v_cmp_eq_u32 vcc, 0, v56
    s_cbranch_vccnz L_lr2
L_lb2:
    buffer_load_dwordx4 v[156:159], v0, s[20:23], s99 offen offset:3072 sc1
    s_waitcnt lgkmcnt(6)
    v_mfma_f32_32x32x16_bf16 v[64:79], v[28:31], v[160:163], v[64:79]
    ds_read_b64_tr_b16 v[24:25], v44 offset:33056
    ds_read_b64_tr_b16 v[26:27], v44 offset:33568
    s_add_u32 s99, s31, 36864
    s_add_u32 m0, s44, 84608
    s_nop 0
    buffer_load_dwordx4 v0, s[20:23], s99 offen sc1 lds
    s_waitcnt lgkmcnt(6)
    v_mfma_f32_32x32x16_bf16 v[80:95], v[32:35], v[160:163], v[80:95]
    v_smfmac_f32_16x16x64_bf16 v[12:15], v[8:11], v[28:35], v16
    ds_read_b64_tr_b16 v[28:29], v1 offset:16512
    ds_read_b64_tr_b16 v[30:31], v1 offset:17024
    s_add_u32 m0, s44, 87680
    s_nop 0
    buffer_load_dwordx4 v0, s[20:23], s99 offen offset:1024 sc1 lds
    s_waitcnt lgkmcnt(6)
    v_mfma_f32_32x32x16_bf16 v[64:79], v[36:39], v[164:167], v[64:79]
    ds_read_b64_tr_b16 v[32:33], v44 offset:16512
    ds_read_b64_tr_b16 v[34:35], v44 offset:17024
    s_add_u32 m0, s44, 90752
    s_nop 0
    buffer_load_dwordx4 v0, s[20:23], s99 offen offset:2048 sc1 lds
    s_waitcnt lgkmcnt(6)
    v_mfma_f32_32x32x16_bf16 v[64:79], v[20:23], v[176:179], v[64:79]
    ds_read_b64_tr_b16 v[36:37], v45 offset:33024
    ds_read_b64_tr_b16 v[38:39], v45 offset:33536
    s_add_u32 m0, s44, 93824
    s_nop 0
    buffer_load_dwordx4 v0, s[20:23], s99 offen offset:3072 sc1 lds
    s_waitcnt lgkmcnt(6)
    v_mfma_f32_32x32x16_bf16 v[80:95], v[24:27], v[176:179], v[80:95]
    v_smfmac_f32_16x16x64_bf16 v[12:15], v[8:11], v[20:27], v16
    ds_read_b64_tr_b16 v[20:21], v1 offset:16544
    ds_read_b64_tr_b16 v[22:23], v1 offset:17056
    s_add_u32 s99, s31, 16384
    buffer_load_dwordx4 v[160:163], v0, s[20:23], s99 offen offset:0 sc1
    s_waitcnt lgkmcnt(6)
    v_mfma_f32_32x32x16_bf16 v[64:79], v[28:31], v[192:195], v[64:79]
    ds_read_b64_tr_b16 v[24:25], v44 offset:16544
    ds_read_b64_tr_b16 v[26:27], v44 offset:17056
    buffer_load_dwordx4 v[176:179], v0, s[20:23], s99 offen offset:1024 sc1
    s_waitcnt lgkmcnt(6)
    v_mfma_f32_32x32x16_bf16 v[80:95], v[32:35], v[192:195], v[80:95]
    v_smfmac_f32_16x16x64_bf16 v[12:15], v[8:11], v[28:35], v16
    v_add_u32 v1, -16512, v1
    ds_read_b64_tr_b16 v[28:29], v1 offset:0
    ds_read_b64_tr_b16 v[30:31], v1 offset:512
    buffer_load_dwordx4 v[192:195], v0, s[20:23], s99 offen offset:2048 sc1
    s_waitcnt lgkmcnt(6)
    v_mfma_f32_32x32x16_bf16 v[80:95], v[36:39], v[164:167], v[80:95]
    v_add_u32 v44, -16512, v44
    ds_read_b64_tr_b16 v[32:33], v44 offset:0
    ds_read_b64_tr_b16 v[34:35], v44 offset:512
    buffer_load_dwordx4 v[164:167], v0, s[20:23], s99 offen offset:3072 sc1
    s_waitcnt lgkmcnt(6)
    v_mfma_f32_32x32x16_bf16 v[64:79], v[20:23], v[208:211], v[64:79]
    ds_read_b64_tr_b16 v[36:37], v3 offset:33024
    ds_read_b64_tr_b16 v[38:39], v3 offset:33536
    s_waitcnt lgkmcnt(6)
    v_mfma_f32_32x32x16_bf16 v[80:95], v[24:27], v[208:211], v[80:95]
    v_smfmac_f32_16x16x64_bf16 v[12:15], v[8:11], v[20:27], v16
    ds_read_b64_tr_b16 v[20:21], v1 offset:32
    ds_read_b64_tr_b16 v[22:23], v1 offset:544
    s_add_u32 s99, s31, 20480
    buffer_load_dwordx4 v[208:211], v0, s[20:23], s99 offen offset:0 sc1
    s_waitcnt lgkmcnt(6)
    v_mfma_f32_32x32x16_bf16 v[64:79], v[28:31], v[224:227], v[64:79]
    ds_read_b64_tr_b16 v[24:25], v44 offset:32
    ds_read_b64_tr_b16 v[26:27], v44 offset:544
    s_waitcnt lgkmcnt(6)
    v_mfma_f32_32x32x16_bf16 v[80:95], v[32:35], v[224:227], v[80:95]
    v_smfmac_f32_16x16x64_bf16 v[12:15], v[8:11], v[28:35], v16
    ds_read_b64_tr_b16 v[28:29], v46 offset:33024
    ds_read_b64_tr_b16 v[30:31], v46 offset:33536
    buffer_load_dwordx4 v[224:227], v0, s[20:23], s99 offen offset:1024 sc1
    s_waitcnt lgkmcnt(6)
    v_mfma_f32_32x32x16_bf16 v[64:79], v[36:39], v[168:171], v[64:79]
    ds_read_b64_tr_b16 v[32:33], v4 offset:33024
    ds_read_b64_tr_b16 v[34:35], v4 offset:33536
    s_waitcnt lgkmcnt(6)
    v_mfma_f32_32x32x16_bf16 v[64:79], v[20:23], v[240:243], v[64:79]
    ds_read_b64_tr_b16 v[36:37], v47 offset:33024
    ds_read_b64_tr_b16 v[38:39], v47 offset:33536
    s_waitcnt lgkmcnt(6)
    v_mfma_f32_32x32x16_bf16 v[80:95], v[24:27], v[240:243], v[80:95]
    v_smfmac_f32_16x16x64_bf16 v[12:15], v[8:11], v[20:27], v16
    ds_read_b64_tr_b16 v[20:21], v2 offset:33056
    ds_read_b64_tr_b16 v[22:23], v2 offset:33568
    buffer_load_dwordx4 v[240:243], v0, s[20:23], s99 offen offset:2048 sc1
    s_waitcnt lgkmcnt(6)
    v_mfma_f32_32x32x16_bf16 v[80:95], v[28:31], v[168:171], v[80:95]
    ds_read_b64_tr_b16 v[24:25], v45 offset:33056
    ds_read_b64_tr_b16 v[26:27], v45 offset:33568
    buffer_load_dwordx4 v[168:171], v0, s[20:23], s99 offen offset:3072 sc1
    s_waitcnt lgkmcnt(6)
    v_mfma_f32_32x32x16_bf16 v[64:79], v[32:35], v[172:175], v[64:79]
    ds_read_b64_tr_b16 v[28:29], v3 offset:33056
    ds_read_b64_tr_b16 v[30:31], v3 offset:33568
    s_lshl_b32 s0, s37, 10
    v_add_f32 v12, v12, v13
    v_add_u32 v17, s0, v0
    v_lshl_add_u32 v13, s36, 2, v17
    ds_write_b32 v13, v12 offset:0
    s_lshl2_add_u32 s0, s36, 101120
    s_mov_b64 exec, 1
    v_mov_b32 v41, s0
    ds_write_b32 v41, v41
    s_mov_b64 exec, -1
    v_and_b32 v8, 0x300, v0
    v_add3_u32 v8, v8, v0, s55
    s_waitcnt lgkmcnt(8)
    v_mfma_f32_32x32x16_bf16 v[80:95], v[36:39], v[172:175], v[80:95]
    ds_read_b64_tr_b16 v[32:33], v46 offset:33056
    ds_read_b64_tr_b16 v[34:35], v46 offset:33568
    s_add_u32 s99, s31, 24576
    buffer_load_dwordx4 v[172:175], v0, s[20:23], s99 offen offset:0 sc1
    s_waitcnt lgkmcnt(8)
    v_mfma_f32_32x32x16_bf16 v[64:79], v[20:23], v[180:183], v[64:79]
    ds_read_b64_tr_b16 v[36:37], v4 offset:33056
    ds_read_b64_tr_b16 v[38:39], v4 offset:33568
    s_waitcnt lgkmcnt(8)
    v_mfma_f32_32x32x16_bf16 v[80:95], v[24:27], v[180:183], v[80:95]
    ds_read_b64_tr_b16 v[20:21], v47 offset:33056
    ds_read_b64_tr_b16 v[22:23], v47 offset:33568
    buffer_load_dwordx4 v[180:183], v0, s[20:23], s99 offen offset:1024 sc1
    s_waitcnt lgkmcnt(8)
    v_mfma_f32_32x32x16_bf16 v[64:79], v[28:31], v[184:187], v[64:79]
    ds_read_b64_tr_b16 v[24:25], v2 offset:16512
    ds_read_b64_tr_b16 v[26:27], v2 offset:17024
    s_waitcnt lgkmcnt(6)
    v_mfma_f32_32x32x16_bf16 v[80:95], v[32:35], v[184:187], v[80:95]
    ds_read_b64_tr_b16 v[28:29], v45 offset:16512
    ds_read_b64_tr_b16 v[30:31], v45 offset:17024
    buffer_load_dwordx4 v[184:187], v0, s[20:23], s99 offen offset:2048 sc1
    s_waitcnt lgkmcnt(6)
    v_mfma_f32_32x32x16_bf16 v[64:79], v[36:39], v[188:191], v[64:79]
    ds_read_b64_tr_b16 v[32:33], v3 offset:16512
    ds_read_b64_tr_b16 v[34:35], v3 offset:17024
    s_waitcnt lgkmcnt(6)
    v_mfma_f32_32x32x16_bf16 v[80:95], v[20:23], v[188:191], v[80:95]
    ds_read_b64_tr_b16 v[36:37], v46 offset:16512
    ds_read_b64_tr_b16 v[38:39], v46 offset:17024
    buffer_load_dwordx4 v[188:191], v0, s[20:23], s99 offen offset:3072 sc1
    s_waitcnt lgkmcnt(6)
    v_mfma_f32_32x32x16_bf16 v[64:79], v[24:27], v[196:199], v[64:79]
    ds_read_b64_tr_b16 v[20:21], v4 offset:16512
    ds_read_b64_tr_b16 v[22:23], v4 offset:17024
    v_and_b32 v11, 0xf0, v0
    v_lshlrev_b32 v11, 3, v11
    buffer_load_dword v10, v11, s[20:23], s30 offen offset:8 sc1
    s_waitcnt lgkmcnt(6)
    v_mfma_f32_32x32x16_bf16 v[80:95], v[28:31], v[196:199], v[80:95]
    ds_read_b64_tr_b16 v[24:25], v47 offset:16512
    ds_read_b64_tr_b16 v[26:27], v47 offset:17024
    s_add_u32 s99, s31, 28672
    buffer_load_dwordx4 v[196:199], v0, s[20:23], s99 offen offset:0 sc1
    s_waitcnt lgkmcnt(6)
    v_mfma_f32_32x32x16_bf16 v[64:79], v[32:35], v[200:203], v[64:79]
    ds_read_b64_tr_b16 v[28:29], v2 offset:16544
    ds_read_b64_tr_b16 v[30:31], v2 offset:17056
    s_waitcnt lgkmcnt(6)
    v_mfma_f32_32x32x16_bf16 v[80:95], v[36:39], v[200:203], v[80:95]
    ds_read_b64_tr_b16 v[32:33], v45 offset:16544
    ds_read_b64_tr_b16 v[34:35], v45 offset:17056
    v_mov_b32 v5, 101120
    ds_read_b128 v[56:59], v5
    ds_read_b128 v[12:15], v17 offset:0
    buffer_load_dwordx4 v[200:203], v0, s[20:23], s99 offen offset:1024 sc1
    s_waitcnt lgkmcnt(8)
    v_mfma_f32_32x32x16_bf16 v[64:79], v[20:23], v[204:207], v[64:79]
    ds_read_b64_tr_b16 v[36:37], v3 offset:16544
    ds_read_b64_tr_b16 v[38:39], v3 offset:17056
    s_waitcnt lgkmcnt(8)
    v_mfma_f32_32x32x16_bf16 v[80:95], v[24:27], v[204:207], v[80:95]
    ds_read_b64_tr_b16 v[20:21], v46 offset:16544
    ds_read_b64_tr_b16 v[22:23], v46 offset:17056
    buffer_load_dwordx4 v[204:207], v0, s[20:23], s99 offen offset:2048 sc1
    s_waitcnt lgkmcnt(8)
    v_mfma_f32_32x32x16_bf16 v[64:79], v[28:31], v[212:215], v[64:79]
    ds_read_b64_tr_b16 v[24:25], v4 offset:16544
    ds_read_b64_tr_b16 v[26:27], v4 offset:17056
    s_waitcnt lgkmcnt(8)
    v_mfma_f32_32x32x16_bf16 v[80:95], v[32:35], v[212:215], v[80:95]
    ds_read_b64_tr_b16 v[28:29], v47 offset:16544
    ds_read_b64_tr_b16 v[30:31], v47 offset:17056
    s_waitcnt lgkmcnt(9)
    v_min3_u32 v56, v56, v57, v58
    v_min_u32 v56, v56, v59
    v_cmp_eq_u32 vcc, 0, v56
    s_cbranch_vccnz L_lr0
L_lb0:
    s_waitcnt lgkmcnt(8)
    v_add_f32 v12, v12, v13
    v_add_f32 v14, v14, v15
    v_mov_b32 v17, 0
    v_add_f32 v12, v12, v14
    v_mov_b32 v18, 0
    v_cvt_pk_bf16_f32 v13, v12, v12
    v_and_b32 v13, 0xffff0000, v13
    v_sub_f32 v12, v12, v13
    v_cvt_pk_bf16_f32 v16, v13, v12
    v_cvt_pk_bf16_f32 v19, v13, v12
    buffer_load_dwordx4 v[212:215], v0, s[20:23], s99 offen offset:3072 sc1
    s_waitcnt lgkmcnt(6)
    v_mfma_f32_32x32x16_bf16 v[64:79], v[36:39], v[216:219], v[64:79]
    v_add_u32 v2, -16512, v2
    ds_read_b64_tr_b16 v[32:33], v2 offset:0
    ds_read_b64_tr_b16 v[34:35], v2 offset:512
    v_mfma_f32_32x32x8_bf16 v[64:79], v[16:17], v[6:7], v[64:79]
    s_add_u32 s99, s31, 40960
    s_add_u32 m0, s44, 35072
    s_nop 0
    buffer_load_dwordx4 v0, s[20:23], s99 offen sc1 lds
    s_waitcnt lgkmcnt(6)
    v_mfma_f32_32x32x16_bf16 v[80:95], v[20:23], v[216:219], v[80:95]
    v_add_u32 v3, -16512, v3
    ds_read_b64_tr_b16 v[36:37], v3 offset:0
    ds_read_b64_tr_b16 v[38:39], v3 offset:512
    v_mfma_f32_32x32x8_bf16 v[80:95], v[18:19], v[6:7], v[80:95]
    s_add_u32 m0, s44, 38144
    s_nop 0
    buffer_load_dwordx4 v0, s[20:23], s99 offen offset:1024 sc1 lds
    s_waitcnt lgkmcnt(6)
    v_mfma_f32_32x32x16_bf16 v[64:79], v[24:27], v[220:223], v[64:79]
    s_add_u32 s0, s44, 2048
    v_add_u32 v12, s0, v0
    s_add_u32 s0, s44, 84608
    v_add_u32 v13, s0, v0
    s_add_u32 s0, s44, 35072
    v_add_u32 v14, s0, v0
    v_add_u32 v4, -16512, v4
    ds_read_b64_tr_b16 v[20:21], v4 offset:0
    ds_read_b64_tr_b16 v[22:23], v4 offset:512
    s_add_u32 m0, s44, 41216
    s_nop 0
    buffer_load_dwordx4 v0, s[20:23], s99 offen offset:2048 sc1 lds
    s_waitcnt lgkmcnt(6)
    v_mfma_f32_32x32x16_bf16 v[80:95], v[28:31], v[220:223], v[80:95]
    ds_read_b64_tr_b16 v[24:25], v2 offset:32
    ds_read_b64_tr_b16 v[26:27], v2 offset:544
    s_add_u32 m0, s44, 44288
    s_nop 0
    buffer_load_dwordx4 v0, s[20:23], s99 offen offset:3072 sc1 lds
    s_waitcnt lgkmcnt(6)
    v_mfma_f32_32x32x16_bf16 v[64:79], v[32:35], v[228:231], v[64:79]
    ds_read_b64_tr_b16 v[28:29], v3 offset:32
    ds_read_b64_tr_b16 v[30:31], v3 offset:544
    s_waitcnt lgkmcnt(6)
    v_mfma_f32_32x32x16_bf16 v[64:79], v[36:39], v[232:235], v[64:79]
    ds_read_b64_tr_b16 v[32:33], v4 offset:32
    ds_read_b64_tr_b16 v[34:35], v4 offset:544
    s_waitcnt lgkmcnt(6)
    v_mfma_f32_32x32x16_bf16 v[64:79], v[20:23], v[236:239], v[64:79]
    v_add_u32 v45, -16512, v45
    ds_read_b64_tr_b16 v[36:37], v45 offset:0
    ds_read_b64_tr_b16 v[38:39], v45 offset:512
    s_waitcnt vmcnt(8)
    v_cmp_ne_u32 s[0:1], s45, v10
    s_cmp_lg_u64 s[0:1], 0
    s_cbranch_scc1 Lfl_10_e
Lfd_9:
    s_lshl2_add_u32 s0, s36, 101168
    s_mov_b64 exec, 1
    v_mov_b32 v41, s0
    ds_write_b32 v41, v41
    s_mov_b64 exec, -1
    s_mov_b32 s98, 0
    buffer_load_dwordx4 v[216:219], v8, s[20:23], s98 offen offset:0 sc1
    s_waitcnt lgkmcnt(7)
    v_mfma_f32_32x32x16_bf16 v[64:79], v[24:27], v[244:247], v[64:79]
    v_add_u32 v46, -16512, v46
    ds_read_b64_tr_b16 v[20:21], v46 offset:0
    ds_read_b64_tr_b16 v[22:23], v46 offset:512
    buffer_load_dwordx4 v[220:223], v8, s[20:23], s98 offen offset:256 sc1
    s_waitcnt lgkmcnt(7)
    v_mfma_f32_32x32x16_bf16 v[64:79], v[28:31], v[248:251], v[64:79]
    v_add_u32 v47, -16512, v47
    ds_read_b64_tr_b16 v[24:25], v47 offset:0
    ds_read_b64_tr_b16 v[26:27], v47 offset:512
    s_waitcnt lgkmcnt(7)
    v_mfma_f32_32x32x16_bf16 v[64:79], v[32:35], v[252:255], v[64:79]
    ds_read_b64_tr_b16 v[28:29], v45 offset:32
    ds_read_b64_tr_b16 v[30:31], v45 offset:544
    s_waitcnt lgkmcnt(7)
    v_mfma_f32_32x32x16_bf16 v[80:95], v[36:39], v[228:231], v[80:95]
    ds_read_b64_tr_b16 v[32:33], v46 offset:32
    ds_read_b64_tr_b16 v[34:35], v46 offset:544
    buffer_load_dwordx4 v[228:231], v8, s[20:23], s98 offen offset:2048 sc1
    s_waitcnt lgkmcnt(6)
    v_mfma_f32_32x32x16_bf16 v[80:95], v[20:23], v[232:235], v[80:95]
    ds_read_b64_tr_b16 v[36:37], v47 offset:32
    ds_read_b64_tr_b16 v[38:39], v47 offset:544
    buffer_load_dwordx4 v[232:235], v8, s[20:23], s98 offen offset:2304 sc1
    v_max_f32 v64, 0, v64
    v_mul_f32 v72, v40, v72
    v_max_f32 v65, 0, v65
    v_mul_f32 v73, v40, v73
    v_mul_f32 v64, v64, v72
    v_mul_f32 v65, v65, v73
    v_cvt_pk_bf16_f32 v64, v64, v65
    s_waitcnt lgkmcnt(6)
    v_mfma_f32_32x32x16_bf16 v[80:95], v[24:27], v[236:239], v[80:95]
    s_mov_b32 s98, 4096
    buffer_load_dwordx4 v[236:239], v8, s[20:23], s98 offen offset:0 sc1
    v_max_f32 v66, 0, v66
    v_mul_f32 v74, v40, v74
    v_max_f32 v67, 0, v67
    v_mul_f32 v75, v40, v75
    v_mul_f32 v66, v66, v74
    v_mul_f32 v67, v67, v75
    v_cvt_pk_bf16_f32 v65, v66, v67
    s_waitcnt lgkmcnt(4)
    v_mfma_f32_32x32x16_bf16 v[80:95], v[28:31], v[244:247], v[80:95]
    buffer_load_dwordx4 v[244:247], v8, s[20:23], s98 offen offset:256 sc1
    v_max_f32 v68, 0, v68
    v_mul_f32 v76, v40, v76
    v_max_f32 v69, 0, v69
    v_mul_f32 v77, v40, v77
    v_mul_f32 v68, v68, v76
    v_mul_f32 v69, v69, v77
    v_cvt_pk_bf16_f32 v66, v68, v69
    s_waitcnt lgkmcnt(2)
    v_mfma_f32_32x32x16_bf16 v[80:95], v[32:35], v[248:251], v[80:95]
    buffer_load_dwordx4 v[248:251], v8, s[20:23], s98 offen offset:2048 sc1
    v_max_f32 v70, 0, v70
    v_mul_f32 v78, v40, v78
    v_max_f32 v71, 0, v71
    v_mul_f32 v79, v40, v79
    v_mul_f32 v70, v70, v78
    v_mul_f32 v71, v71, v79
    v_cvt_pk_bf16_f32 v67, v70, v71
    s_waitcnt lgkmcnt(0)
    v_mfma_f32_32x32x16_bf16 v[80:95], v[36:39], v[252:255], v[80:95]
    buffer_load_dwordx4 v[252:255], v8, s[20:23], s98 offen offset:2304 sc1
    v_min_u32 v64, -2, v64
    v_min_u32 v65, -2, v65
    v_min_u32 v66, -2, v66
    v_min_u32 v67, -2, v67
    buffer_store_dwordx4 v[64:67], v0, s[20:23], s33 offen offset:0 sc1
    s_nop 5
    v_max_f32 v80, 0, v80
    v_mul_f32 v88, v40, v88
    v_max_f32 v81, 0, v81
    v_mul_f32 v89, v40, v89
    v_mul_f32 v80, v80, v88
    v_mul_f32 v81, v81, v89
    v_cvt_pk_bf16_f32 v80, v80, v81
    v_max_f32 v82, 0, v82
    v_mul_f32 v90, v40, v90
    v_max_f32 v83, 0, v83
    v_mul_f32 v91, v40, v91
    v_mul_f32 v82, v82, v90
    v_mul_f32 v83, v83, v91
    v_cvt_pk_bf16_f32 v81, v82, v83
    v_max_f32 v84, 0, v84
    v_mul_f32 v92, v40, v92
    v_max_f32 v85, 0, v85
    v_mul_f32 v93, v40, v93
    v_mul_f32 v84, v84, v92
    v_mul_f32 v85, v85, v93
    v_cvt_pk_bf16_f32 v82, v84, v85
    v_max_f32 v86, 0, v86
    v_mul_f32 v94, v40, v94
    v_max_f32 v87, 0, v87
    v_mul_f32 v95, v40, v95
    v_mul_f32 v86, v86, v94
    v_mul_f32 v87, v87, v95
    v_cvt_pk_bf16_f32 v83, v86, v87
    v_min_u32 v80, -2, v80
    v_min_u32 v81, -2, v81
    v_min_u32 v82, -2, v82
    v_min_u32 v83, -2, v83
    buffer_store_dwordx4 v[80:83], v0, s[20:23], s33 offen offset:1024 sc1
    s_setprio 3
    s_waitcnt vmcnt(9)
    v_mfma_f32_16x16x32_bf16 v[16:19], v[96:99], v[216:219], 0
    s_waitcnt vmcnt(8)
    v_mfma_f32_16x16x32_bf16 v[20:23], v[96:99], v[220:223], 0
    s_waitcnt vmcnt(7)
    v_mfma_f32_16x16x32_bf16 v[24:27], v[96:99], v[228:231], 0
    s_waitcnt vmcnt(6)
    v_mfma_f32_16x16x32_bf16 v[28:31], v[96:99], v[232:235], 0
    s_mov_b32 s98, 8192
    buffer_load_dwordx4 v[96:99], v8, s[20:23], s98 offen offset:0 sc1
    v_mfma_f32_16x16x32_bf16 v[32:35], v[112:115], v[216:219], 0
    v_mfma_f32_16x16x32_bf16 v[36:39], v[112:115], v[220:223], 0
    v_mfma_f32_16x16x32_bf16 v[40:43], v[112:115], v[228:231], 0
    v_mfma_f32_16x16x32_bf16 v[44:47], v[112:115], v[232:235], 0
    buffer_load_dwordx4 v[112:115], v8, s[20:23], s98 offen offset:256 sc1
    v_mfma_f32_16x16x32_bf16 v[48:51], v[100:103], v[216:219], 0
    v_mfma_f32_16x16x32_bf16 v[52:55], v[100:103], v[220:223], 0
    v_mfma_f32_16x16x32_bf16 v[56:59], v[100:103], v[228:231], 0
    v_mfma_f32_16x16x32_bf16 v[60:63], v[100:103], v[232:235], 0
    buffer_load_dwordx4 v[100:103], v8, s[20:23], s98 offen offset:2048 sc1
    v_mfma_f32_16x16x32_bf16 v[64:67], v[104:107], v[216:219], 0
    v_mfma_f32_16x16x32_bf16 v[68:71], v[104:107], v[220:223], 0
    v_mfma_f32_16x16x32_bf16 v[72:75], v[104:107], v[228:231], 0
    v_mfma_f32_16x16x32_bf16 v[76:79], v[104:107], v[232:235], 0
    buffer_load_dwordx4 v[104:107], v8, s[20:23], s98 offen offset:2304 sc1
    v_mfma_f32_16x16x32_bf16 v[80:83], v[108:111], v[216:219], 0
    s_mov_b32 s98, 12288
    buffer_load_dwordx4 v[216:219], v8, s[20:23], s98 offen offset:0 sc1
    v_mfma_f32_16x16x32_bf16 v[84:87], v[108:111], v[220:223], 0
    buffer_load_dwordx4 v[220:223], v8, s[20:23], s98 offen offset:256 sc1
    v_mfma_f32_16x16x32_bf16 v[88:91], v[108:111], v[228:231], 0
    buffer_load_dwordx4 v[228:231], v8, s[20:23], s98 offen offset:2048 sc1
    v_mfma_f32_16x16x32_bf16 v[92:95], v[108:111], v[232:235], 0
    buffer_load_dwordx4 v[108:111], v8, s[20:23], s98 offen offset:2304 sc1
    s_waitcnt vmcnt(13)
    v_mfma_f32_16x16x32_bf16 v[16:19], v[116:119], v[236:239], v[16:19]
    s_mov_b32 s98, 16384
    buffer_load_dwordx4 v[232:235], v8, s[20:23], s98 offen offset:0 sc1
    s_mul_i32 s47, s36, 20480
    s_add_u32 s47, s47, 0
    v_add_u32 v9, s47, v0
    s_waitcnt vmcnt(13)
    v_mfma_f32_16x16x32_bf16 v[20:23], v[116:119], v[244:247], v[20:23]
    s_waitcnt vmcnt(12)
    v_mfma_f32_16x16x32_bf16 v[24:27], v[116:119], v[248:251], v[24:27]
    s_waitcnt vmcnt(11)
    v_mfma_f32_16x16x32_bf16 v[28:31], v[116:119], v[252:255], v[28:31]
    buffer_load_dwordx4 v[116:119], v8, s[20:23], s98 offen offset:256 sc1
    v_mfma_f32_16x16x32_bf16 v[32:35], v[120:123], v[236:239], v[32:35]
    v_mfma_f32_16x16x32_bf16 v[36:39], v[120:123], v[244:247], v[36:39]
    v_mfma_f32_16x16x32_bf16 v[40:43], v[120:123], v[248:251], v[40:43]
    v_mfma_f32_16x16x32_bf16 v[44:47], v[120:123], v[252:255], v[44:47]
    buffer_load_dwordx4 v[120:123], v8, s[20:23], s98 offen offset:2048 sc1
    v_mfma_f32_16x16x32_bf16 v[48:51], v[124:127], v[236:239], v[48:51]
    v_mfma_f32_16x16x32_bf16 v[52:55], v[124:127], v[244:247], v[52:55]
    v_mfma_f32_16x16x32_bf16 v[56:59], v[124:127], v[248:251], v[56:59]
    v_mfma_f32_16x16x32_bf16 v[60:63], v[124:127], v[252:255], v[60:63]
    buffer_load_dwordx4 v[124:127], v8, s[20:23], s98 offen offset:2304 sc1
    v_mfma_f32_16x16x32_bf16 v[64:67], v[128:131], v[236:239], v[64:67]
    v_mfma_f32_16x16x32_bf16 v[68:71], v[128:131], v[244:247], v[68:71]
    v_mfma_f32_16x16x32_bf16 v[72:75], v[128:131], v[248:251], v[72:75]
    v_mfma_f32_16x16x32_bf16 v[76:79], v[128:131], v[252:255], v[76:79]
    s_mov_b32 s98, 20480
    buffer_load_dwordx4 v[128:131], v8, s[20:23], s98 offen offset:0 sc1
    v_mfma_f32_16x16x32_bf16 v[80:83], v[144:147], v[236:239], v[80:83]
    buffer_load_dwordx4 v[236:239], v8, s[20:23], s98 offen offset:256 sc1
    v_mfma_f32_16x16x32_bf16 v[84:87], v[144:147], v[244:247], v[84:87]
    buffer_load_dwordx4 v[244:247], v8, s[20:23], s98 offen offset:2048 sc1
    v_mfma_f32_16x16x32_bf16 v[88:91], v[144:147], v[248:251], v[88:91]
    buffer_load_dwordx4 v[248:251], v8, s[20:23], s98 offen offset:2304 sc1
    v_mfma_f32_16x16x32_bf16 v[92:95], v[144:147], v[252:255], v[92:95]
    s_mov_b32 s98, 24576
    buffer_load_dwordx4 v[144:147], v8, s[20:23], s98 offen offset:0 sc1
    s_waitcnt vmcnt(16)
    v_mfma_f32_16x16x32_bf16 v[16:19], v[132:135], v[96:99], v[16:19]
    buffer_load_dwordx4 v[252:255], v8, s[20:23], s98 offen offset:256 sc1
    s_waitcnt vmcnt(16)
    v_mfma_f32_16x16x32_bf16 v[20:23], v[132:135], v[112:115], v[20:23]
    s_waitcnt vmcnt(15)
    v_mfma_f32_16x16x32_bf16 v[24:27], v[132:135], v[100:103], v[24:27]
    s_waitcnt vmcnt(14)
    v_mfma_f32_16x16x32_bf16 v[28:31], v[132:135], v[104:107], v[28:31]
    buffer_load_dwordx4 v[132:135], v8, s[20:23], s98 offen offset:2048 sc1
    v_mfma_f32_16x16x32_bf16 v[32:35], v[136:139], v[96:99], v[32:35]
    v_mfma_f32_16x16x32_bf16 v[36:39], v[136:139], v[112:115], v[36:39]
    v_mfma_f32_16x16x32_bf16 v[40:43], v[136:139], v[100:103], v[40:43]
    v_mfma_f32_16x16x32_bf16 v[44:47], v[136:139], v[104:107], v[44:47]
    buffer_load_dwordx4 v[136:139], v8, s[20:23], s98 offen offset:2304 sc1
    v_mfma_f32_16x16x32_bf16 v[48:51], v[140:143], v[96:99], v[48:51]
    v_mfma_f32_16x16x32_bf16 v[52:55], v[140:143], v[112:115], v[52:55]
    v_mfma_f32_16x16x32_bf16 v[56:59], v[140:143], v[100:103], v[56:59]
    v_mfma_f32_16x16x32_bf16 v[60:63], v[140:143], v[104:107], v[60:63]
    ds_read_b128 v[140:143], v12 offset:0
    v_mfma_f32_16x16x32_bf16 v[64:67], v[148:151], v[96:99], v[64:67]
    v_mfma_f32_16x16x32_bf16 v[68:71], v[148:151], v[112:115], v[68:71]
    v_mfma_f32_16x16x32_bf16 v[72:75], v[148:151], v[100:103], v[72:75]
    v_mfma_f32_16x16x32_bf16 v[76:79], v[148:151], v[104:107], v[76:79]
    ds_read_b128 v[148:151], v12 offset:4096
    v_mfma_f32_16x16x32_bf16 v[80:83], v[152:155], v[96:99], v[80:83]
    ds_read_b128 v[96:99], v12 offset:8192
    v_mfma_f32_16x16x32_bf16 v[84:87], v[152:155], v[112:115], v[84:87]
    s_mov_b32 s98, 28672
    buffer_load_dwordx4 v[112:115], v8, s[20:23], s98 offen offset:0 sc1
    v_mfma_f32_16x16x32_bf16 v[88:91], v[152:155], v[100:103], v[88:91]
    buffer_load_dwordx4 v[100:103], v8, s[20:23], s98 offen offset:256 sc1
    v_mfma_f32_16x16x32_bf16 v[92:95], v[152:155], v[104:107], v[92:95]
    buffer_load_dwordx4 v[152:155], v8, s[20:23], s98 offen offset:2048 sc1
    s_waitcnt vmcnt(18)
    v_mfma_f32_16x16x32_bf16 v[16:19], v[156:159], v[216:219], v[16:19]
    buffer_load_dwordx4 v[104:107], v8, s[20:23], s98 offen offset:2304 sc1
    s_waitcnt vmcnt(18)
    v_mfma_f32_16x16x32_bf16 v[20:23], v[156:159], v[220:223], v[20:23]
    s_waitcnt vmcnt(17)
    v_mfma_f32_16x16x32_bf16 v[24:27], v[156:159], v[228:231], v[24:27]
    s_waitcnt vmcnt(16)
    v_mfma_f32_16x16x32_bf16 v[28:31], v[156:159], v[108:111], v[28:31]
    ds_read_b128 v[156:159], v12 offset:12288
    v_mfma_f32_16x16x32_bf16 v[32:35], v[160:163], v[216:219], v[32:35]
    v_mfma_f32_16x16x32_bf16 v[36:39], v[160:163], v[220:223], v[36:39]
    v_mfma_f32_16x16x32_bf16 v[40:43], v[160:163], v[228:231], v[40:43]
    v_mfma_f32_16x16x32_bf16 v[44:47], v[160:163], v[108:111], v[44:47]
    ds_read_b128 v[160:163], v13 offset:0
    v_mfma_f32_16x16x32_bf16 v[48:51], v[176:179], v[216:219], v[48:51]
    v_mfma_f32_16x16x32_bf16 v[52:55], v[176:179], v[220:223], v[52:55]
    v_mfma_f32_16x16x32_bf16 v[56:59], v[176:179], v[228:231], v[56:59]
    v_mfma_f32_16x16x32_bf16 v[60:63], v[176:179], v[108:111], v[60:63]
    ds_read_b128 v[176:179], v13 offset:4096
    v_mfma_f32_16x16x32_bf16 v[64:67], v[192:195], v[216:219], v[64:67]
    v_mfma_f32_16x16x32_bf16 v[68:71], v[192:195], v[220:223], v[68:71]
    v_mfma_f32_16x16x32_bf16 v[72:75], v[192:195], v[228:231], v[72:75]
    v_mfma_f32_16x16x32_bf16 v[76:79], v[192:195], v[108:111], v[76:79]
    ds_read_b128 v[192:195], v13 offset:8192
    v_mfma_f32_16x16x32_bf16 v[80:83], v[164:167], v[216:219], v[80:83]
    ds_read_b128 v[216:219], v13 offset:12288
    v_mfma_f32_16x16x32_bf16 v[84:87], v[164:167], v[220:223], v[84:87]
    v_mfma_f32_16x16x32_bf16 v[88:91], v[164:167], v[228:231], v[88:91]
    v_mfma_f32_16x16x32_bf16 v[92:95], v[164:167], v[108:111], v[92:95]
    s_waitcnt vmcnt(15)
    v_mfma_f32_16x16x32_bf16 v[16:19], v[208:211], v[232:235], v[16:19]
    s_mov_b32 s98, 32768
    buffer_load_dwordx4 v[220:223], v8, s[20:23], s98 offen offset:0 sc1
    s_waitcnt vmcnt(15)
    v_mfma_f32_16x16x32_bf16 v[20:23], v[208:211], v[116:119], v[20:23]
    buffer_load_dwordx4 v[228:231], v8, s[20:23], s98 offen offset:256 sc1
    s_waitcnt vmcnt(15)
    v_mfma_f32_16x16x32_bf16 v[24:27], v[208:211], v[120:123], v[24:27]
    buffer_load_dwordx4 v[164:167], v8, s[20:23], s98 offen offset:2048 sc1
    s_waitcnt vmcnt(15)
    v_mfma_f32_16x16x32_bf16 v[28:31], v[208:211], v[124:127], v[28:31]
    buffer_load_dwordx4 v[108:111], v8, s[20:23], s98 offen offset:2304 sc1
    v_mfma_f32_16x16x32_bf16 v[32:35], v[224:227], v[232:235], v[32:35]
    ds_read_b128 v[208:211], v14 offset:0
    v_mfma_f32_16x16x32_bf16 v[36:39], v[224:227], v[116:119], v[36:39]
    v_mfma_f32_16x16x32_bf16 v[40:43], v[224:227], v[120:123], v[40:43]
    v_mfma_f32_16x16x32_bf16 v[44:47], v[224:227], v[124:127], v[44:47]
    ds_read_b128 v[224:227], v14 offset:4096
    v_mfma_f32_16x16x32_bf16 v[48:51], v[240:243], v[232:235], v[48:51]
    v_mfma_f32_16x16x32_bf16 v[52:55], v[240:243], v[116:119], v[52:55]
    v_mfma_f32_16x16x32_bf16 v[56:59], v[240:243], v[120:123], v[56:59]
    v_mfma_f32_16x16x32_bf16 v[60:63], v[240:243], v[124:127], v[60:63]
    ds_read_b128 v[240:243], v14 offset:8192
    v_mfma_f32_16x16x32_bf16 v[64:67], v[168:171], v[232:235], v[64:67]
    v_mfma_f32_16x16x32_bf16 v[68:71], v[168:171], v[116:119], v[68:71]
    v_mfma_f32_16x16x32_bf16 v[72:75], v[168:171], v[120:123], v[72:75]
    v_mfma_f32_16x16x32_bf16 v[76:79], v[168:171], v[124:127], v[76:79]
    ds_read_b128 v[168:171], v14 offset:12288
    v_mfma_f32_16x16x32_bf16 v[80:83], v[172:175], v[232:235], v[80:83]
    s_add_u32 s99, s31, 45056
    buffer_load_dwordx4 v[232:235], v0, s[20:23], s99 offen offset:0 sc1
    v_mfma_f32_16x16x32_bf16 v[84:87], v[172:175], v[116:119], v[84:87]
    s_mov_b32 s98, 36864
    buffer_load_dwordx4 v[116:119], v8, s[20:23], s98 offen offset:0 sc1
    v_mfma_f32_16x16x32_bf16 v[88:91], v[172:175], v[120:123], v[88:91]
    buffer_load_dwordx4 v[120:123], v8, s[20:23], s98 offen offset:256 sc1
    v_mfma_f32_16x16x32_bf16 v[92:95], v[172:175], v[124:127], v[92:95]
    buffer_load_dwordx4 v[172:175], v8, s[20:23], s98 offen offset:2048 sc1
    s_waitcnt vmcnt(19)
    v_mfma_f32_16x16x32_bf16 v[16:19], v[180:183], v[128:131], v[16:19]
    buffer_load_dwordx4 v[124:127], v8, s[20:23], s98 offen offset:2304 sc1
    s_waitcnt vmcnt(19)
    v_mfma_f32_16x16x32_bf16 v[20:23], v[180:183], v[236:239], v[20:23]
    s_waitcnt vmcnt(18)
    v_mfma_f32_16x16x32_bf16 v[24:27], v[180:183], v[244:247], v[24:27]
    s_waitcnt vmcnt(17)
    v_mfma_f32_16x16x32_bf16 v[28:31], v[180:183], v[248:251], v[28:31]
    buffer_load_dwordx4 v[180:183], v0, s[20:23], s99 offen offset:1024 sc1
    v_mfma_f32_16x16x32_bf16 v[32:35], v[184:187], v[128:131], v[32:35]
    v_mfma_f32_16x16x32_bf16 v[36:39], v[184:187], v[236:239], v[36:39]
    v_mfma_f32_16x16x32_bf16 v[40:43], v[184:187], v[244:247], v[40:43]
    v_mfma_f32_16x16x32_bf16 v[44:47], v[184:187], v[248:251], v[44:47]
    buffer_load_dwordx4 v[184:187], v0, s[20:23], s99 offen offset:2048 sc1
    v_mfma_f32_16x16x32_bf16 v[48:51], v[188:191], v[128:131], v[48:51]
    v_mfma_f32_16x16x32_bf16 v[52:55], v[188:191], v[236:239], v[52:55]
    v_mfma_f32_16x16x32_bf16 v[56:59], v[188:191], v[244:247], v[56:59]
    v_mfma_f32_16x16x32_bf16 v[60:63], v[188:191], v[248:251], v[60:63]
    buffer_load_dwordx4 v[188:191], v0, s[20:23], s99 offen offset:3072 sc1
    v_mfma_f32_16x16x32_bf16 v[64:67], v[196:199], v[128:131], v[64:67]
    v_mfma_f32_16x16x32_bf16 v[68:71], v[196:199], v[236:239], v[68:71]
    v_mfma_f32_16x16x32_bf16 v[72:75], v[196:199], v[244:247], v[72:75]
    v_mfma_f32_16x16x32_bf16 v[76:79], v[196:199], v[248:251], v[76:79]
    s_add_u32 s99, s31, 49152
    buffer_load_dwordx4 v[196:199], v0, s[20:23], s99 offen offset:0 sc1
    v_mfma_f32_16x16x32_bf16 v[80:83], v[200:203], v[128:131], v[80:83]
    buffer_load_dwordx4 v[128:131], v0, s[20:23], s99 offen offset:1024 sc1
    v_mfma_f32_16x16x32_bf16 v[84:87], v[200:203], v[236:239], v[84:87]
    s_mov_b32 s98, 40960
    buffer_load_dwordx4 v[236:239], v8, s[20:23], s98 offen offset:0 sc1
    v_mfma_f32_16x16x32_bf16 v[88:91], v[200:203], v[244:247], v[88:91]
    buffer_load_dwordx4 v[244:247], v8, s[20:23], s98 offen offset:256 sc1
    v_mfma_f32_16x16x32_bf16 v[92:95], v[200:203], v[248:251], v[92:95]
    buffer_load_dwordx4 v[200:203], v8, s[20:23], s98 offen offset:2048 sc1
    s_waitcnt vmcnt(24)
    v_mfma_f32_16x16x32_bf16 v[16:19], v[204:207], v[144:147], v[16:19]
    buffer_load_dwordx4 v[248:251], v8, s[20:23], s98 offen offset:2304 sc1
    s_waitcnt vmcnt(24)
    v_mfma_f32_16x16x32_bf16 v[20:23], v[204:207], v[252:255], v[20:23]
    s_waitcnt vmcnt(23)
    v_mfma_f32_16x16x32_bf16 v[24:27], v[204:207], v[132:135], v[24:27]
    s_waitcnt vmcnt(22)
    v_mfma_f32_16x16x32_bf16 v[28:31], v[204:207], v[136:139], v[28:31]
    buffer_load_dwordx4 v[204:207], v0, s[20:23], s99 offen offset:2048 sc1
    v_mfma_f32_16x16x32_bf16 v[32:35], v[212:215], v[144:147], v[32:35]
    v_mfma_f32_16x16x32_bf16 v[36:39], v[212:215], v[252:255], v[36:39]
    v_mfma_f32_16x16x32_bf16 v[40:43], v[212:215], v[132:135], v[40:43]
    v_mfma_f32_16x16x32_bf16 v[44:47], v[212:215], v[136:139], v[44:47]
    buffer_load_dwordx4 v[212:215], v0, s[20:23], s99 offen offset:3072 sc1
    s_waitcnt lgkmcnt(11)
    v_mfma_f32_16x16x32_bf16 v[48:51], v[140:143], v[144:147], v[48:51]
    v_mfma_f32_16x16x32_bf16 v[52:55], v[140:143], v[252:255], v[52:55]
    v_mfma_f32_16x16x32_bf16 v[56:59], v[140:143], v[132:135], v[56:59]
    v_mfma_f32_16x16x32_bf16 v[60:63], v[140:143], v[136:139], v[60:63]
    s_add_u32 s99, s31, 53248
    buffer_load_dwordx4 v[140:143], v0, s[20:23], s99 offen offset:0 sc1
    s_waitcnt lgkmcnt(10)
    v_mfma_f32_16x16x32_bf16 v[64:67], v[148:151], v[144:147], v[64:67]
    v_mfma_f32_16x16x32_bf16 v[68:71], v[148:151], v[252:255], v[68:71]
    v_mfma_f32_16x16x32_bf16 v[72:75], v[148:151], v[132:135], v[72:75]
    v_mfma_f32_16x16x32_bf16 v[76:79], v[148:151], v[136:139], v[76:79]
    buffer_load_dwordx4 v[148:151], v0, s[20:23], s99 offen offset:1024 sc1
    s_waitcnt lgkmcnt(9)
    v_mfma_f32_16x16x32_bf16 v[80:83], v[96:99], v[144:147], v[80:83]
    buffer_load_dwordx4 v[144:147], v0, s[20:23], s99 offen offset:2048 sc1
    v_mfma_f32_16x16x32_bf16 v[84:87], v[96:99], v[252:255], v[84:87]
    s_mov_b32 s98, 45056
    buffer_load_dwordx4 v[252:255], v8, s[20:23], s98 offen offset:0 sc1
    v_mfma_f32_16x16x32_bf16 v[88:91], v[96:99], v[132:135], v[88:91]
    buffer_load_dwordx4 v[132:135], v8, s[20:23], s98 offen offset:256 sc1
    v_mfma_f32_16x16x32_bf16 v[92:95], v[96:99], v[136:139], v[92:95]
    buffer_load_dwordx4 v[96:99], v8, s[20:23], s98 offen offset:2048 sc1
    s_waitcnt vmcnt(29) lgkmcnt(8)
    v_mfma_f32_16x16x32_bf16 v[16:19], v[156:159], v[112:115], v[16:19]
    buffer_load_dwordx4 v[136:139], v8, s[20:23], s98 offen offset:2304 sc1
    s_waitcnt vmcnt(29)
    v_mfma_f32_16x16x32_bf16 v[20:23], v[156:159], v[100:103], v[20:23]
    s_waitcnt vmcnt(28)
    v_mfma_f32_16x16x32_bf16 v[24:27], v[156:159], v[152:155], v[24:27]
    s_waitcnt vmcnt(27)
    v_mfma_f32_16x16x32_bf16 v[28:31], v[156:159], v[104:107], v[28:31]
    buffer_load_dwordx4 v[156:159], v0, s[20:23], s99 offen offset:3072 sc1
    s_waitcnt lgkmcnt(7)
    v_mfma_f32_16x16x32_bf16 v[32:35], v[160:163], v[112:115], v[32:35]
    v_mfma_f32_16x16x32_bf16 v[36:39], v[160:163], v[100:103], v[36:39]
    v_mfma_f32_16x16x32_bf16 v[40:43], v[160:163], v[152:155], v[40:43]
    v_mfma_f32_16x16x32_bf16 v[44:47], v[160:163], v[104:107], v[44:47]
    s_add_u32 s99, s31, 57344
    buffer_load_dwordx4 v[160:163], v0, s[20:23], s99 offen offset:0 sc1
    s_waitcnt lgkmcnt(6)
    v_mfma_f32_16x16x32_bf16 v[48:51], v[176:179], v[112:115], v[48:51]
    v_mfma_f32_16x16x32_bf16 v[52:55], v[176:179], v[100:103], v[52:55]
    v_mfma_f32_16x16x32_bf16 v[56:59], v[176:179], v[152:155], v[56:59]
    v_mfma_f32_16x16x32_bf16 v[60:63], v[176:179], v[104:107], v[60:63]
    buffer_load_dwordx4 v[176:179], v0, s[20:23], s99 offen offset:1024 sc1
    s_waitcnt lgkmcnt(5)
    v_mfma_f32_16x16x32_bf16 v[64:67], v[192:195], v[112:115], v[64:67]
    v_mfma_f32_16x16x32_bf16 v[68:71], v[192:195], v[100:103], v[68:71]
    v_mfma_f32_16x16x32_bf16 v[72:75], v[192:195], v[152:155], v[72:75]
    v_mfma_f32_16x16x32_bf16 v[76:79], v[192:195], v[104:107], v[76:79]
    buffer_load_dwordx4 v[192:195], v0, s[20:23], s99 offen offset:2048 sc1
    s_waitcnt lgkmcnt(4)
    v_mfma_f32_16x16x32_bf16 v[80:83], v[216:219], v[112:115], v[80:83]
    buffer_load_dwordx4 v[112:115], v0, s[20:23], s99 offen offset:3072 sc1
    v_mfma_f32_16x16x32_bf16 v[84:87], v[216:219], v[100:103], v[84:87]
    v_mfma_f32_16x16x32_bf16 v[88:91], v[216:219], v[152:155], v[88:91]
    v_mfma_f32_16x16x32_bf16 v[92:95], v[216:219], v[104:107], v[92:95]
    s_waitcnt vmcnt(31)
    v_max3_u32 v6, v220, v221, v222
    s_waitcnt vmcnt(30)
    v_max3_u32 v7, v223, v228, v229
    v_max3_u32 v6, v6, v230, v231
    s_waitcnt vmcnt(29)
    v_max3_u32 v7, v7, v164, v165
    v_max3_u32 v6, v6, v166, v167
    s_waitcnt vmcnt(28)
    v_max3_u32 v7, v7, v108, v109
    v_max3_u32 v6, v6, v110, v111
    v_max_u32 v6, v6, v7
    v_cmp_eq_u32 vcc, -1, v6
    s_cbranch_vccnz L_hrg8
L_hbg8:
    s_waitcnt lgkmcnt(3)
    v_mfma_f32_16x16x32_bf16 v[16:19], v[208:211], v[220:223], v[16:19]
    v_mfma_f32_16x16x32_bf16 v[20:23], v[208:211], v[228:231], v[20:23]
    v_mfma_f32_16x16x32_bf16 v[24:27], v[208:211], v[164:167], v[24:27]
    v_mfma_f32_16x16x32_bf16 v[28:31], v[208:211], v[108:111], v[28:31]
    s_waitcnt lgkmcnt(2)
    v_mfma_f32_16x16x32_bf16 v[32:35], v[224:227], v[220:223], v[32:35]
    v_mfma_f32_16x16x32_bf16 v[36:39], v[224:227], v[228:231], v[36:39]
    v_mfma_f32_16x16x32_bf16 v[40:43], v[224:227], v[164:167], v[40:43]
    v_mfma_f32_16x16x32_bf16 v[44:47], v[224:227], v[108:111], v[44:47]
    s_waitcnt lgkmcnt(1)
    v_mfma_f32_16x16x32_bf16 v[48:51], v[240:243], v[220:223], v[48:51]
    v_mfma_f32_16x16x32_bf16 v[52:55], v[240:243], v[228:231], v[52:55]
    v_mfma_f32_16x16x32_bf16 v[56:59], v[240:243], v[164:167], v[56:59]
    v_mfma_f32_16x16x32_bf16 v[60:63], v[240:243], v[108:111], v[60:63]
    s_waitcnt lgkmcnt(0)
    v_mfma_f32_16x16x32_bf16 v[64:67], v[168:171], v[220:223], v[64:67]
    v_mfma_f32_16x16x32_bf16 v[68:71], v[168:171], v[228:231], v[68:71]
    v_mfma_f32_16x16x32_bf16 v[72:75], v[168:171], v[164:167], v[72:75]
    v_mfma_f32_16x16x32_bf16 v[76:79], v[168:171], v[108:111], v[76:79]
    s_waitcnt vmcnt(27)
    v_mfma_f32_16x16x32_bf16 v[80:83], v[232:235], v[220:223], v[80:83]
    v_mfma_f32_16x16x32_bf16 v[84:87], v[232:235], v[228:231], v[84:87]
    v_mfma_f32_16x16x32_bf16 v[88:91], v[232:235], v[164:167], v[88:91]
    v_mfma_f32_16x16x32_bf16 v[92:95], v[232:235], v[108:111], v[92:95]
    s_setprio 0
    s_lshl2_add_u32 s0, s36, 101136
    s_mov_b64 exec, 1
    v_mov_b32 v15, s0
    ds_write_b32 v15, v15
    s_mov_b64 exec, -1
    s_waitcnt vmcnt(26)
    v_max3_u32 v6, v116, v117, v118
    s_waitcnt vmcnt(25)
    v_max3_u32 v7, v119, v120, v121
    v_max3_u32 v6, v6, v122, v123
    s_waitcnt vmcnt(24)
    v_max3_u32 v7, v7, v172, v173
    v_max3_u32 v6, v6, v174, v175
    s_waitcnt vmcnt(23)
    v_max3_u32 v7, v7, v124, v125
    v_max3_u32 v6, v6, v126, v127
    v_max_u32 v6, v6, v7
    v_cmp_eq_u32 vcc, -1, v6
    s_cbranch_vccnz L_hrg9
L_hbg9:
    s_waitcnt vmcnt(22)
    v_mfma_f32_16x16x32_bf16 v[16:19], v[180:183], v[116:119], v[16:19]
    v_mfma_f32_16x16x32_bf16 v[20:23], v[180:183], v[120:123], v[20:23]
    v_mfma_f32_16x16x32_bf16 v[24:27], v[180:183], v[172:175], v[24:27]
    v_mfma_f32_16x16x32_bf16 v[28:31], v[180:183], v[124:127], v[28:31]
    s_waitcnt vmcnt(21)
    v_mfma_f32_16x16x32_bf16 v[32:35], v[184:187], v[116:119], v[32:35]
    v_mfma_f32_16x16x32_bf16 v[36:39], v[184:187], v[120:123], v[36:39]
    v_mfma_f32_16x16x32_bf16 v[40:43], v[184:187], v[172:175], v[40:43]
    v_mfma_f32_16x16x32_bf16 v[44:47], v[184:187], v[124:127], v[44:47]
    s_waitcnt vmcnt(20)
    v_mfma_f32_16x16x32_bf16 v[48:51], v[188:191], v[116:119], v[48:51]
    v_mfma_f32_16x16x32_bf16 v[52:55], v[188:191], v[120:123], v[52:55]
    v_mfma_f32_16x16x32_bf16 v[56:59], v[188:191], v[172:175], v[56:59]
    v_mfma_f32_16x16x32_bf16 v[60:63], v[188:191], v[124:127], v[60:63]
    s_waitcnt vmcnt(19)
    v_mfma_f32_16x16x32_bf16 v[64:67], v[196:199], v[116:119], v[64:67]
    v_mfma_f32_16x16x32_bf16 v[68:71], v[196:199], v[120:123], v[68:71]
    v_mfma_f32_16x16x32_bf16 v[72:75], v[196:199], v[172:175], v[72:75]
    v_mfma_f32_16x16x32_bf16 v[76:79], v[196:199], v[124:127], v[76:79]
    s_waitcnt vmcnt(18)
    v_mfma_f32_16x16x32_bf16 v[80:83], v[128:131], v[116:119], v[80:83]
    v_mfma_f32_16x16x32_bf16 v[84:87], v[128:131], v[120:123], v[84:87]
    v_mfma_f32_16x16x32_bf16 v[88:91], v[128:131], v[172:175], v[88:91]
    v_mfma_f32_16x16x32_bf16 v[92:95], v[128:131], v[124:127], v[92:95]
    v_mov_b32 v5, 101136
    ds_read_b128 v[120:123], v5
    s_waitcnt vmcnt(17)
    v_max3_u32 v6, v236, v237, v238
    s_waitcnt vmcnt(16)
    v_max3_u32 v7, v239, v244, v245
    v_max3_u32 v6, v6, v246, v247
    s_waitcnt vmcnt(15)
    v_max3_u32 v7, v7, v200, v201
    v_max3_u32 v6, v6, v202, v203
    s_waitcnt vmcnt(14)
    v_max3_u32 v7, v7, v248, v249
    v_max3_u32 v6, v6, v250, v251
    v_max_u32 v6, v6, v7
    v_cmp_eq_u32 vcc, -1, v6
    s_cbranch_vccnz L_hrg10
L_hbg10:
    s_waitcnt vmcnt(13)
    v_mfma_f32_16x16x32_bf16 v[16:19], v[204:207], v[236:239], v[16:19]
    s_lshl2_add_u32 s47, s53, s36
    s_mul_i32 s47, s47, 20480
    s_mul_i32 s48, s54, 160
    s_add_u32 s47, s47, s48
    v_mfma_f32_16x16x32_bf16 v[20:23], v[204:207], v[244:247], v[20:23]
    v_bfe_u32 v10, v0, 4, 4
    v_mul_u32_u24 v10, 1280, v10
    v_lshrrev_b32 v11, 8, v0
    v_lshl_add_u32 v10, v11, 3, v10
    v_mfma_f32_16x16x32_bf16 v[24:27], v[204:207], v[200:203], v[24:27]
    v_add_u32 v10, s47, v10
    v_lshl_add_u32 v14, s36, 10, v0
    v_add_u32 v11, 81920, v14
    v_add_u32 v12, 122880, v14
    v_mfma_f32_16x16x32_bf16 v[28:31], v[204:207], v[248:251], v[28:31]
    v_add_u32 v13, 0, v14
    v_add_u32 v14, 40960, v14
    s_waitcnt vmcnt(12)
    v_mfma_f32_16x16x32_bf16 v[32:35], v[212:215], v[236:239], v[32:35]
    buffer_load_dwordx2 v[124:125], v10, s[4:7], 0 offen offset:0
    v_mfma_f32_16x16x32_bf16 v[36:39], v[212:215], v[244:247], v[36:39]
    buffer_load_dwordx2 v[126:127], v10, s[4:7], 0 offen offset:32
    v_mfma_f32_16x16x32_bf16 v[40:43], v[212:215], v[200:203], v[40:43]
    buffer_load_dwordx2 v[128:129], v10, s[4:7], 0 offen offset:64
    v_mfma_f32_16x16x32_bf16 v[44:47], v[212:215], v[248:251], v[44:47]
    buffer_load_dwordx2 v[130:131], v10, s[4:7], 0 offen offset:96
    s_waitcnt vmcnt(15)
    v_mfma_f32_16x16x32_bf16 v[48:51], v[140:143], v[236:239], v[48:51]
    buffer_load_dwordx2 v[172:173], v10, s[4:7], 0 offen offset:128
    v_mfma_f32_16x16x32_bf16 v[52:55], v[140:143], v[244:247], v[52:55]
    v_mfma_f32_16x16x32_bf16 v[56:59], v[140:143], v[200:203], v[56:59]
    v_mfma_f32_16x16x32_bf16 v[60:63], v[140:143], v[248:251], v[60:63]
    s_waitcnt vmcnt(15)
    v_mfma_f32_16x16x32_bf16 v[64:67], v[148:151], v[236:239], v[64:67]
    v_mfma_f32_16x16x32_bf16 v[68:71], v[148:151], v[244:247], v[68:71]
    v_mfma_f32_16x16x32_bf16 v[72:75], v[148:151], v[200:203], v[72:75]
    v_mfma_f32_16x16x32_bf16 v[76:79], v[148:151], v[248:251], v[76:79]
    s_waitcnt vmcnt(14)
    v_mfma_f32_16x16x32_bf16 v[80:83], v[144:147], v[236:239], v[80:83]
    v_mfma_f32_16x16x32_bf16 v[84:87], v[144:147], v[244:247], v[84:87]
    v_mfma_f32_16x16x32_bf16 v[88:91], v[144:147], v[200:203], v[88:91]
    v_mfma_f32_16x16x32_bf16 v[92:95], v[144:147], v[248:251], v[92:95]
    s_waitcnt lgkmcnt(0)
    v_min3_u32 v120, v120, v121, v122
    v_min_u32 v120, v120, v123
    v_cmp_eq_u32 vcc, 0, v120
    s_cbranch_vccnz L_lr1
L_lb1:
    s_waitcnt vmcnt(13)
    v_max3_u32 v6, v252, v253, v254
    s_waitcnt vmcnt(12)
    v_max3_u32 v7, v255, v132, v133
    v_max3_u32 v6, v6, v134, v135
    s_waitcnt vmcnt(11)
    v_max3_u32 v7, v7, v96, v97
    v_max3_u32 v6, v6, v98, v99
    s_waitcnt vmcnt(10)
    v_max3_u32 v7, v7, v136, v137
    v_max3_u32 v6, v6, v138, v139
    v_max_u32 v6, v6, v7
    v_cmp_eq_u32 vcc, -1, v6
    s_cbranch_vccnz L_hrg11
L_hbg11:
    s_waitcnt vmcnt(9)
    v_mfma_f32_16x16x32_bf16 v[16:19], v[156:159], v[252:255], v[16:19]
    v_mfma_f32_16x16x32_bf16 v[20:23], v[156:159], v[132:135], v[20:23]
    v_mfma_f32_16x16x32_bf16 v[24:27], v[156:159], v[96:99], v[24:27]
    v_mfma_f32_16x16x32_bf16 v[28:31], v[156:159], v[136:139], v[28:31]
    s_waitcnt vmcnt(8)
    v_mfma_f32_16x16x32_bf16 v[32:35], v[160:163], v[252:255], v[32:35]
    s_nop 2
    ds_write_b128 v9, v[16:19] offset:0
    v_mfma_f32_16x16x32_bf16 v[36:39], v[160:163], v[132:135], v[36:39]
    ds_write_b128 v9, v[20:23] offset:1024
    v_mfma_f32_16x16x32_bf16 v[40:43], v[160:163], v[96:99], v[40:43]
    ds_write_b128 v9, v[24:27] offset:2048
    v_mfma_f32_16x16x32_bf16 v[44:47], v[160:163], v[136:139], v[44:47]
    ds_write_b128 v9, v[28:31] offset:3072
    s_waitcnt vmcnt(7)
    v_mfma_f32_16x16x32_bf16 v[48:51], v[176:179], v[252:255], v[48:51]
    ds_write_b128 v9, v[32:35] offset:4096
    v_mfma_f32_16x16x32_bf16 v[52:55], v[176:179], v[132:135], v[52:55]
    ds_write_b128 v9, v[36:39] offset:5120
    v_mfma_f32_16x16x32_bf16 v[56:59], v[176:179], v[96:99], v[56:59]
    ds_write_b128 v9, v[40:43] offset:6144
    v_mfma_f32_16x16x32_bf16 v[60:63], v[176:179], v[136:139], v[60:63]
    ds_write_b128 v9, v[44:47] offset:7168
    s_waitcnt vmcnt(6)
    v_mfma_f32_16x16x32_bf16 v[64:67], v[192:195], v[252:255], v[64:67]
    ds_write_b128 v9, v[48:51] offset:8192
    v_mfma_f32_16x16x32_bf16 v[68:71], v[192:195], v[132:135], v[68:71]
    ds_write_b128 v9, v[52:55] offset:9216
    v_mfma_f32_16x16x32_bf16 v[72:75], v[192:195], v[96:99], v[72:75]
    ds_write_b128 v9, v[56:59] offset:10240
    v_mfma_f32_16x16x32_bf16 v[76:79], v[192:195], v[136:139], v[76:79]
    ds_write_b128 v9, v[60:63] offset:11264
    s_waitcnt vmcnt(5)
    v_mfma_f32_16x16x32_bf16 v[80:83], v[112:115], v[252:255], v[80:83]
    ds_write_b128 v9, v[64:67] offset:12288
    v_mfma_f32_16x16x32_bf16 v[84:87], v[112:115], v[132:135], v[84:87]
    ds_write_b128 v9, v[68:71] offset:13312
    v_mfma_f32_16x16x32_bf16 v[88:91], v[112:115], v[96:99], v[88:91]
    ds_write_b128 v9, v[72:75] offset:14336
    v_mfma_f32_16x16x32_bf16 v[92:95], v[112:115], v[136:139], v[92:95]
    ds_write_b128 v9, v[76:79] offset:15360
    s_nop 0
    ds_write_b128 v9, v[80:83] offset:16384
    s_nop 0
    ds_write_b128 v9, v[84:87] offset:17408
    s_nop 0
    ds_write_b128 v9, v[88:91] offset:18432
    s_nop 0
    ds_write_b128 v9, v[92:95] offset:19456
    s_waitcnt lgkmcnt(0)
    s_barrier
    ds_read_b128 v[16:19], v13 offset:0
    ds_read_b128 v[20:23], v13 offset:20480
    ds_read_b128 v[24:27], v14 offset:0
    ds_read_b128 v[28:31], v14 offset:20480
    ds_read_b128 v[32:35], v13 offset:4096
    ds_read_b128 v[36:39], v13 offset:24576
    ds_read_b128 v[40:43], v14 offset:4096
    ds_read_b128 v[44:47], v14 offset:24576
    ds_read_b128 v[48:51], v13 offset:8192
    ds_read_b128 v[52:55], v13 offset:28672
    ds_read_b128 v[56:59], v14 offset:8192
    ds_read_b128 v[60:63], v14 offset:28672
    ds_read_b128 v[64:67], v13 offset:12288
    ds_read_b128 v[68:71], v13 offset:32768
    ds_read_b128 v[72:75], v14 offset:12288
    ds_read_b128 v[76:79], v14 offset:32768
    ds_read_b128 v[80:83], v13 offset:16384
    ds_read_b128 v[84:87], v13 offset:36864
    ds_read_b128 v[88:91], v14 offset:16384
    ds_read_b128 v[92:95], v14 offset:36864
    s_waitcnt vmcnt(4)
    v_lshlrev_b32 v136, 16, v124
    v_and_b32 v137, 0xffff0000, v124
    v_lshlrev_b32 v138, 16, v125
    v_and_b32 v139, 0xffff0000, v125
    s_waitcnt vmcnt(3)
    v_lshlrev_b32 v112, 16, v126
    v_and_b32 v113, 0xffff0000, v126
    v_lshlrev_b32 v114, 16, v127
    v_and_b32 v115, 0xffff0000, v127
    s_waitcnt vmcnt(2)
    v_lshlrev_b32 v96, 16, v128
    v_and_b32 v97, 0xffff0000, v128
    v_lshlrev_b32 v98, 16, v129
    v_and_b32 v99, 0xffff0000, v129
    s_waitcnt vmcnt(1)
    v_lshlrev_b32 v132, 16, v130
    v_and_b32 v133, 0xffff0000, v130
    v_lshlrev_b32 v134, 16, v131
    v_and_b32 v135, 0xffff0000, v131
    s_waitcnt vmcnt(0)
    v_lshlrev_b32 v252, 16, v172
    v_and_b32 v253, 0xffff0000, v172
    v_lshlrev_b32 v254, 16, v173
    v_and_b32 v255, 0xffff0000, v173
    s_waitcnt lgkmcnt(15)
    v_pk_add_f32 v[136:137], v[136:137], v[16:17]
    v_pk_add_f32 v[138:139], v[138:139], v[18:19]
    v_pk_add_f32 v[20:21], v[20:21], v[24:25]
    v_pk_add_f32 v[22:23], v[22:23], v[26:27]
    v_pk_add_f32 v[136:137], v[136:137], v[28:29]
    v_pk_add_f32 v[138:139], v[138:139], v[30:31]
    v_pk_add_f32 v[136:137], v[136:137], v[20:21]
    v_pk_add_f32 v[138:139], v[138:139], v[22:23]
    v_pk_add_f32 v[112:113], v[112:113], v[32:33]
    v_pk_add_f32 v[114:115], v[114:115], v[34:35]
    s_waitcnt lgkmcnt(13)
    v_pk_add_f32 v[36:37], v[36:37], v[40:41]
    v_pk_add_f32 v[38:39], v[38:39], v[42:43]
    s_waitcnt lgkmcnt(12)
    v_pk_add_f32 v[112:113], v[112:113], v[44:45]
    v_pk_add_f32 v[114:115], v[114:115], v[46:47]
    v_pk_add_f32 v[112:113], v[112:113], v[36:37]
    v_pk_add_f32 v[114:115], v[114:115], v[38:39]
    s_waitcnt lgkmcnt(11)
    v_pk_add_f32 v[96:97], v[96:97], v[48:49]
    v_pk_add_f32 v[98:99], v[98:99], v[50:51]
    s_waitcnt lgkmcnt(9)
    v_pk_add_f32 v[52:53], v[52:53], v[56:57]
    v_pk_add_f32 v[54:55], v[54:55], v[58:59]
    s_waitcnt lgkmcnt(8)
    v_pk_add_f32 v[96:97], v[96:97], v[60:61]
    v_pk_add_f32 v[98:99], v[98:99], v[62:63]
    v_pk_add_f32 v[96:97], v[96:97], v[52:53]
    v_pk_add_f32 v[98:99], v[98:99], v[54:55]
    s_waitcnt lgkmcnt(7)
    v_pk_add_f32 v[132:133], v[132:133], v[64:65]
    v_pk_add_f32 v[134:135], v[134:135], v[66:67]
    s_waitcnt lgkmcnt(5)
    v_pk_add_f32 v[68:69], v[68:69], v[72:73]
    v_pk_add_f32 v[70:71], v[70:71], v[74:75]
    s_waitcnt lgkmcnt(4)
    v_pk_add_f32 v[132:133], v[132:133], v[76:77]
    v_pk_add_f32 v[134:135], v[134:135], v[78:79]
    v_pk_add_f32 v[132:133], v[132:133], v[68:69]
    v_pk_add_f32 v[134:135], v[134:135], v[70:71]
    s_waitcnt lgkmcnt(3)
    v_pk_add_f32 v[252:253], v[252:253], v[80:81]
    v_pk_add_f32 v[254:255], v[254:255], v[82:83]
    s_waitcnt lgkmcnt(1)
    v_pk_add_f32 v[84:85], v[84:85], v[88:89]
    v_pk_add_f32 v[86:87], v[86:87], v[90:91]
    s_waitcnt lgkmcnt(0)
    v_pk_add_f32 v[252:253], v[252:253], v[92:93]
    v_pk_add_f32 v[254:255], v[254:255], v[94:95]
    v_pk_add_f32 v[252:253], v[252:253], v[84:85]
    v_pk_add_f32 v[254:255], v[254:255], v[86:87]
    s_setprio 3
    s_barrier
    ds_read_b128 v[16:19], v11 offset:0
    ds_read_b128 v[20:23], v11 offset:20480
    ds_read_b128 v[24:27], v12 offset:0
    ds_read_b128 v[28:31], v12 offset:20480
    ds_read_b128 v[32:35], v11 offset:4096
    ds_read_b128 v[36:39], v11 offset:24576
    ds_read_b128 v[40:43], v12 offset:4096
    ds_read_b128 v[44:47], v12 offset:24576
    s_waitcnt lgkmcnt(7)
    v_pk_add_f32 v[136:137], v[136:137], v[16:17]
    v_pk_add_f32 v[138:139], v[138:139], v[18:19]
    s_waitcnt lgkmcnt(5)
    v_pk_add_f32 v[20:21], v[20:21], v[24:25]
    v_pk_add_f32 v[22:23], v[22:23], v[26:27]
    s_waitcnt lgkmcnt(4)
    v_pk_add_f32 v[136:137], v[136:137], v[28:29]
    v_pk_add_f32 v[138:139], v[138:139], v[30:31]
    v_pk_add_f32 v[136:137], v[136:137], v[20:21]
    v_pk_add_f32 v[138:139], v[138:139], v[22:23]
    v_cvt_pk_bf16_f32 v124, v136, v137
    v_cvt_pk_bf16_f32 v125, v138, v139
    buffer_store_dwordx2 v[124:125], v10, s[24:27], 0 offen offset:0
    s_waitcnt lgkmcnt(3)
    v_pk_add_f32 v[112:113], v[112:113], v[32:33]
    v_pk_add_f32 v[114:115], v[114:115], v[34:35]
    s_waitcnt lgkmcnt(1)
    v_pk_add_f32 v[36:37], v[36:37], v[40:41]
    v_pk_add_f32 v[38:39], v[38:39], v[42:43]
    s_waitcnt lgkmcnt(0)
    v_pk_add_f32 v[112:113], v[112:113], v[44:45]
    v_pk_add_f32 v[114:115], v[114:115], v[46:47]
    v_pk_add_f32 v[112:113], v[112:113], v[36:37]
    v_pk_add_f32 v[114:115], v[114:115], v[38:39]
    v_cvt_pk_bf16_f32 v126, v112, v113
    v_cvt_pk_bf16_f32 v127, v114, v115
    buffer_store_dwordx2 v[126:127], v10, s[24:27], 0 offen offset:32
    s_barrier
    ds_read_b128 v[48:51], v11 offset:8192
    ds_read_b128 v[52:55], v11 offset:28672
    ds_read_b128 v[56:59], v12 offset:8192
    ds_read_b128 v[60:63], v12 offset:28672
    s_waitcnt lgkmcnt(3)
    v_pk_add_f32 v[96:97], v[96:97], v[48:49]
    v_pk_add_f32 v[98:99], v[98:99], v[50:51]
    s_waitcnt lgkmcnt(1)
    v_pk_add_f32 v[52:53], v[52:53], v[56:57]
    v_pk_add_f32 v[54:55], v[54:55], v[58:59]
    s_waitcnt lgkmcnt(0)
    v_pk_add_f32 v[96:97], v[96:97], v[60:61]
    v_pk_add_f32 v[98:99], v[98:99], v[62:63]
    v_pk_add_f32 v[96:97], v[96:97], v[52:53]
    v_pk_add_f32 v[98:99], v[98:99], v[54:55]
    v_cvt_pk_bf16_f32 v128, v96, v97
    v_cvt_pk_bf16_f32 v129, v98, v99
    buffer_store_dwordx2 v[128:129], v10, s[24:27], 0 offen offset:64
    s_barrier
    ds_read_b128 v[64:67], v11 offset:12288
    ds_read_b128 v[68:71], v11 offset:32768
    ds_read_b128 v[72:75], v12 offset:12288
    ds_read_b128 v[76:79], v12 offset:32768
    ds_read_b128 v[80:83], v11 offset:16384
    ds_read_b128 v[84:87], v11 offset:36864
    ds_read_b128 v[88:91], v12 offset:16384
    ds_read_b128 v[92:95], v12 offset:36864
    s_waitcnt lgkmcnt(7)
    v_pk_add_f32 v[132:133], v[132:133], v[64:65]
    v_pk_add_f32 v[134:135], v[134:135], v[66:67]
    s_waitcnt lgkmcnt(5)
    v_pk_add_f32 v[68:69], v[68:69], v[72:73]
    v_pk_add_f32 v[70:71], v[70:71], v[74:75]
    s_waitcnt lgkmcnt(4)
    v_pk_add_f32 v[132:133], v[132:133], v[76:77]
    v_pk_add_f32 v[134:135], v[134:135], v[78:79]
    v_pk_add_f32 v[132:133], v[132:133], v[68:69]
    v_pk_add_f32 v[134:135], v[134:135], v[70:71]
    v_cvt_pk_bf16_f32 v130, v132, v133
    v_cvt_pk_bf16_f32 v131, v134, v135
    buffer_store_dwordx2 v[130:131], v10, s[24:27], 0 offen offset:96
    s_waitcnt lgkmcnt(3)
    v_pk_add_f32 v[252:253], v[252:253], v[80:81]
    v_pk_add_f32 v[254:255], v[254:255], v[82:83]
    s_waitcnt lgkmcnt(1)
    v_pk_add_f32 v[84:85], v[84:85], v[88:89]
    v_pk_add_f32 v[86:87], v[86:87], v[90:91]
    s_waitcnt lgkmcnt(0)
    v_pk_add_f32 v[252:253], v[252:253], v[92:93]
    v_pk_add_f32 v[254:255], v[254:255], v[94:95]
    v_pk_add_f32 v[252:253], v[252:253], v[84:85]
    v_pk_add_f32 v[254:255], v[254:255], v[86:87]
    v_cvt_pk_bf16_f32 v172, v252, v253
    v_cvt_pk_bf16_f32 v173, v254, v255
    buffer_store_dwordx2 v[172:173], v10, s[24:27], 0 offen offset:128
L_end:
    s_endpgm
L_A:
    s_waitcnt lgkmcnt(6)
    v_mfma_f32_32x32x16_bf16 v[80:95], v[24:27], v[128:131], v[80:95]
    v_add_u32 v4, 82560, v4
    ds_read_b64_tr_b16 v[20:21], v4 offset:49536
    ds_read_b64_tr_b16 v[22:23], v4 offset:50048
    buffer_store_dwordx4 v[44:47], v0, s[20:23], s95 offen offset:0 sc1
    s_waitcnt lgkmcnt(6)
    v_mfma_f32_32x32x16_bf16 v[48:63], v[28:31], v[128:131], v[48:63]
    v_smfmac_f32_16x16x64_bf16 v[12:15], v[8:11], v[24:31], v16
    ds_read_b64_tr_b16 v[24:25], v2 offset:49568
    ds_read_b64_tr_b16 v[26:27], v2 offset:50080
    s_add_u32 m0, s44, 68096
    s_add_u32 s42, s42, 196608
    s_cmp_eq_u32 s42, 1966080
    s_cselect_b32 s42, 0, s42
    buffer_load_dwordx4 v5, s[12:15], s42 offen lds
    s_waitcnt lgkmcnt(6)
    v_mfma_f32_32x32x16_bf16 v[80:95], v[32:35], v[132:135], v[80:95]
    ds_read_b64_tr_b16 v[28:29], v3 offset:49568
    ds_read_b64_tr_b16 v[30:31], v3 offset:50080
    s_waitcnt lgkmcnt(6)
    v_mfma_f32_32x32x16_bf16 v[80:95], v[36:39], v[136:139], v[80:95]
    ds_read_b64_tr_b16 v[32:33], v4 offset:49568
    ds_read_b64_tr_b16 v[34:35], v4 offset:50080
    s_add_u32 m0, s44, 76320
    s_nop 0
    buffer_load_dwordx4 v5, s[16:19], s42 offen lds
    s_mov_b64 exec, 0xffff
    buffer_store_dwordx4 v[44:47], v0, s[20:23], s40 offen offset:0 sc1
    s_mov_b64 exec, -1
    s_waitcnt lgkmcnt(6)
    v_mfma_f32_32x32x16_bf16 v[80:95], v[20:23], v[140:143], v[80:95]
    s_waitcnt vmcnt(12)
    s_barrier
    ds_read_b64_tr_b16 v[36:37], v1 offset:0
    ds_read_b64_tr_b16 v[38:39], v1 offset:512
    s_waitcnt lgkmcnt(6)
    v_mfma_f32_32x32x16_bf16 v[48:63], v[24:27], v[132:135], v[48:63]
    ds_read_b64_tr_b16 v[20:21], v2 offset:0
    ds_read_b64_tr_b16 v[22:23], v2 offset:512
    s_add_u32 m0, s44, 51584
    s_add_u32 s42, s42, 196608
    s_cmp_eq_u32 s42, 1966080
    s_cselect_b32 s42, 0, s42
    buffer_load_dwordx4 v5, s[12:15], s42 offen lds
    s_waitcnt lgkmcnt(6)
    v_mfma_f32_32x32x16_bf16 v[48:63], v[28:31], v[136:139], v[48:63]
    ds_read_b64_tr_b16 v[24:25], v3 offset:0
    ds_read_b64_tr_b16 v[26:27], v3 offset:512
    buffer_store_dwordx4 v[44:47], v0, s[20:23], s33 offen offset:0 sc1
    s_waitcnt lgkmcnt(6)
    v_mfma_f32_32x32x16_bf16 v[48:63], v[32:35], v[140:143], v[48:63]
    ds_read_b64_tr_b16 v[28:29], v4 offset:0
    ds_read_b64_tr_b16 v[30:31], v4 offset:512
    s_add_u32 m0, s44, 59808
    s_nop 0
    buffer_load_dwordx4 v5, s[16:19], s42 offen lds
    s_waitcnt lgkmcnt(6)
    v_mfma_f32_32x32x16_bf16 v[80:95], v[36:39], v[144:147], v[80:95]
    ds_read_b64_tr_b16 v[32:33], v1 offset:32
    ds_read_b64_tr_b16 v[34:35], v1 offset:544
    s_waitcnt lgkmcnt(6)
    v_mfma_f32_32x32x16_bf16 v[80:95], v[20:23], v[148:151], v[80:95]
    ds_read_b64_tr_b16 v[36:37], v2 offset:32
    ds_read_b64_tr_b16 v[38:39], v2 offset:544
    s_waitcnt lgkmcnt(6)
    v_mfma_f32_32x32x16_bf16 v[80:95], v[24:27], v[152:155], v[80:95]
    ds_read_b64_tr_b16 v[20:21], v3 offset:32
    ds_read_b64_tr_b16 v[22:23], v3 offset:544
    v_bfe_u32 v46, v0, 4, 5
    v_lshrrev_b32 v47, 9, v0
    v_lshlrev_b32 v47, 2, v47
    v_sub_u32 v46, v46, v47
    s_waitcnt lgkmcnt(6)
    v_mfma_f32_32x32x16_bf16 v[80:95], v[28:31], v[156:159], v[80:95]
    ds_read_b64_tr_b16 v[24:25], v4 offset:32
    ds_read_b64_tr_b16 v[26:27], v4 offset:544
    v_cmp_gt_i32 s[56:57], 0, v46
    v_cmp_gt_i32 s[58:59], 1, v46
    v_cmp_gt_i32 s[60:61], 2, v46
    v_cmp_gt_i32 s[62:63], 3, v46
    s_waitcnt lgkmcnt(6)
    v_mfma_f32_32x32x16_bf16 v[48:63], v[32:35], v[144:147], v[48:63]
    v_smfmac_f32_16x16x64_bf16 v[12:15], v[8:11], v[28:35], v16
    s_waitcnt vmcnt(9)
    s_barrier
    v_add_u32 v1, -49536, v1
    ds_read_b64_tr_b16 v[28:29], v1 offset:0
    ds_read_b64_tr_b16 v[30:31], v1 offset:512
    v_cmp_gt_i32 s[64:65], 8, v46
    v_cmp_gt_i32 s[66:67], 9, v46
    v_cmp_gt_i32 s[68:69], 10, v46
    v_cmp_gt_i32 s[70:71], 11, v46
    s_waitcnt lgkmcnt(6)
    v_mfma_f32_32x32x16_bf16 v[48:63], v[36:39], v[148:151], v[48:63]
    v_add_u32 v2, -49536, v2
    ds_read_b64_tr_b16 v[32:33], v2 offset:0
    ds_read_b64_tr_b16 v[34:35], v2 offset:512
    s_add_u32 m0, s44, 18560
    s_add_u32 s42, s42, 196608
    s_cmp_eq_u32 s42, 1966080
    s_cselect_b32 s42, 0, s42
    buffer_load_dwordx4 v5, s[12:15], s42 offen lds
    v_cmp_gt_i32 s[72:73], 16, v46
    v_cmp_gt_i32 s[74:75], 17, v46
    v_cmp_gt_i32 s[76:77], 18, v46
    v_cmp_gt_i32 s[78:79], 19, v46
    s_waitcnt lgkmcnt(6)
    v_mfma_f32_32x32x16_bf16 v[48:63], v[20:23], v[152:155], v[48:63]
    v_add_u32 v3, -49536, v3
    ds_read_b64_tr_b16 v[36:37], v3 offset:0
    ds_read_b64_tr_b16 v[38:39], v3 offset:512
    v_cmp_gt_i32 s[80:81], 24, v46
    v_cmp_gt_i32 s[82:83], 25, v46
    v_cmp_gt_i32 s[84:85], 26, v46
    v_cmp_gt_i32 s[86:87], 27, v46
    s_waitcnt lgkmcnt(6)
    v_mfma_f32_32x32x16_bf16 v[48:63], v[24:27], v[156:159], v[48:63]
    v_add_u32 v4, -49536, v4
    ds_read_b64_tr_b16 v[20:21], v4 offset:0
    ds_read_b64_tr_b16 v[22:23], v4 offset:512
    s_add_u32 m0, s44, 26784
    s_nop 0
    buffer_load_dwordx4 v5, s[16:19], s42 offen lds
    s_mul_i32 s97, s36, 5152
    s_add_u32 s97, s97, 102016
    v_lshrrev_b32 v45, 9, v0
    v_lshlrev_b32 v46, 6, v45
    v_xor_b32 v46, v46, v0
    v_add_u32 v124, s97, v46
    s_waitcnt lgkmcnt(6)
    v_mfma_f32_32x32x16_bf16 v[80:95], v[28:31], v[160:163], v[80:95]
    ds_read_b64_tr_b16 v[24:25], v1 offset:32
    ds_read_b64_tr_b16 v[26:27], v1 offset:544
    v_and_b32 v44, 0x1f0, v0
    v_mov_b32 v47, 4096
    v_cndmask_b32 v44, v44, v47, s[90:91]
    s_add_u32 s47, s97, 1024
    v_add_u32 v126, s47, v44
    s_waitcnt lgkmcnt(6)
    v_mfma_f32_32x32x16_bf16 v[80:95], v[32:35], v[164:167], v[80:95]
    ds_read_b64_tr_b16 v[28:29], v2 offset:32
    ds_read_b64_tr_b16 v[30:31], v2 offset:544
    s_add_u32 m0, s44, 2048
    s_add_u32 s42, s42, 196608
    s_cmp_eq_u32 s42, 1966080
    s_cselect_b32 s42, 0, s42
    buffer_load_dwordx4 v5, s[12:15], s42 offen lds
    s_add_u32 s47, s97, 1536
    v_xor_b32 v46, 64, v46
    v_add_u32 v125, s47, v46
    v_cndmask_b32 v44, 8, 0, s[90:91]
    v_add_u32 v127, v44, v126
    s_waitcnt lgkmcnt(6)
    v_mfma_f32_32x32x16_bf16 v[80:95], v[36:39], v[168:171], v[80:95]
    ds_read_b64_tr_b16 v[32:33], v3 offset:32
    ds_read_b64_tr_b16 v[34:35], v3 offset:544
    v_and_b32 v117, 0x130, v0
    s_movk_i32 s47, 0xff
    s_movk_i32 s48, 0x100
    v_cmp_lt_u32 vcc, s47, v117
    v_cmp_lt_u32 s[50:51], s48, v117
    v_bfe_u32 v44, v0, 5, 1
    s_waitcnt lgkmcnt(6)
    v_mfma_f32_32x32x16_bf16 v[80:95], v[20:23], v[172:175], v[80:95]
    ds_read_b64_tr_b16 v[36:37], v4 offset:32
    ds_read_b64_tr_b16 v[38:39], v4 offset:544
    s_add_u32 m0, s44, 10272
    s_nop 0
    buffer_load_dwordx4 v5, s[16:19], s42 offen lds
    v_bfe_u32 v46, v0, 4, 1
    v_cndmask_b32 v44, v44, 2, vcc
    v_cndmask_b32 v46, v46, 0, vcc
    v_lshlrev_b32 v116, 3, v46
    s_waitcnt lgkmcnt(6)
    v_mfma_f32_32x32x16_bf16 v[48:63], v[24:27], v[160:163], v[48:63]
    v_smfmac_f32_16x16x64_bf16 v[12:15], v[8:11], v[20:27], v16
    s_waitcnt vmcnt(11)
    s_barrier
    v_add_u32 v1, 33024, v1
    ds_read_b64_tr_b16 v[20:21], v1 offset:49536
    ds_read_b64_tr_b16 v[22:23], v1 offset:50048
    s_add_u32 s99, s31, 61440
    buffer_load_dwordx4 v[128:131], v0, s[20:23], s99 offen offset:0 sc1
    v_lshl_add_u32 v116, v44, 9, v116
    v_xor_b32 v44, v44, v45
    v_and_b32 v44, 1, v44
    v_xor_b32 v44, 1, v44
    s_waitcnt lgkmcnt(6)
    v_mfma_f32_32x32x16_bf16 v[48:63], v[28:31], v[164:167], v[48:63]
    v_add_u32 v2, 33024, v2
    ds_read_b64_tr_b16 v[24:25], v2 offset:49536
    ds_read_b64_tr_b16 v[26:27], v2 offset:50048
    s_add_u32 s42, s42, 196608
    s_cmp_eq_u32 s42, 1966080
    s_cselect_b32 s42, 0, s42
    s_mul_i32 s0, s39, 123136
    s_lshl1_add_u32 s0, s44, s0
    s_lshr_b32 s42, s42, 4
    s_add_u32 s0, s0, 19582976
    v_add_u32 v5, s0, v0
    s_add_u32 m0, s44, 84608
    s_nop 0
    buffer_load_dwordx4 v5, s[20:23], s42 offen sc1 lds
    v_lshl_add_u32 v116, v44, 6, v116
    v_bfe_u32 v44, v0, 6, 2
    v_lshl_add_u32 v116, v44, 4, v116
    v_xor_b32 v120, 64, v116
    s_waitcnt lgkmcnt(6)
    v_mfma_f32_32x32x16_bf16 v[48:63], v[32:35], v[168:171], v[48:63]
    v_add_u32 v3, 33024, v3
    ds_read_b64_tr_b16 v[28:29], v3 offset:49536
    ds_read_b64_tr_b16 v[30:31], v3 offset:50048
    buffer_load_dwordx4 v[132:135], v0, s[20:23], s99 offen offset:1024 sc1
    v_add_u32 v120, 1536, v120
    v_add_u32 v44, 8, v116
    v_cndmask_b32 v120, v120, v44, vcc
    v_mov_b32 v44, 2568
    s_waitcnt lgkmcnt(6)
    v_mfma_f32_32x32x16_bf16 v[48:63], v[36:39], v[172:175], v[48:63]
    v_add_u32 v4, 33024, v4
    ds_read_b64_tr_b16 v[32:33], v4 offset:49536
    ds_read_b64_tr_b16 v[34:35], v4 offset:50048
    s_add_u32 m0, s44, 91808
    s_nop 0
    buffer_load_dwordx4 v5, s[20:23], s42 offen offset:1024 sc1 lds
    v_mov_b32 v46, 128
    v_cndmask_b32 v116, v116, v44, s[50:51]
    v_cndmask_b32 v120, v120, v44, s[50:51]
    v_cndmask_b32 v46, v46, 0, s[50:51]
    s_waitcnt lgkmcnt(6)
    v_mfma_f32_32x32x16_bf16 v[80:95], v[20:23], v[176:179], v[80:95]
    ds_read_b64_tr_b16 v[36:37], v1 offset:49568
    ds_read_b64_tr_b16 v[38:39], v1 offset:50080
    buffer_load_dwordx4 v[136:139], v0, s[20:23], s99 offen offset:2048 sc1
    s_add_u32 s47, s97, 2560
    v_add_u32 v116, s47, v116
    v_add_u32 v120, s47, v120
    v_add_u32 v117, v116, v46
    v_add_u32 v118, v117, v46
    s_waitcnt lgkmcnt(6)
    v_mfma_f32_32x32x16_bf16 v[80:95], v[24:27], v[180:183], v[80:95]
    ds_read_b64_tr_b16 v[20:21], v2 offset:49568
    ds_read_b64_tr_b16 v[22:23], v2 offset:50080
    buffer_load_dwordx4 v[140:143], v0, s[20:23], s99 offen offset:3072 sc1
    v_add_u32 v119, v118, v46
    v_add_u32 v121, v120, v46
    v_add_u32 v122, v121, v46
    v_add_u32 v123, v122, v46
    v_mov_b32 v44, 0xffff0000
    s_waitcnt lgkmcnt(6)
    v_mfma_f32_32x32x16_bf16 v[80:95], v[28:31], v[184:187], v[80:95]
    ds_read_b64_tr_b16 v[24:25], v3 offset:49568
    ds_read_b64_tr_b16 v[26:27], v3 offset:50080
    s_add_u32 s99, s31, 65536
    buffer_load_dwordx4 v[144:147], v0, s[20:23], s99 offen offset:0 sc1
    v_cndmask_b32 v108, 0, v44, s[58:59]
    v_cndmask_b32 v108, v108, -1, s[56:57]
    v_cndmask_b32 v109, 0, v44, s[62:63]
    v_cndmask_b32 v109, v109, -1, s[60:61]
    s_waitcnt lgkmcnt(6)
    v_mfma_f32_32x32x16_bf16 v[80:95], v[32:35], v[188:191], v[80:95]
    ds_read_b64_tr_b16 v[28:29], v4 offset:49568
    ds_read_b64_tr_b16 v[30:31], v4 offset:50080
    buffer_load_dwordx4 v[148:151], v0, s[20:23], s99 offen offset:1024 sc1
    v_cndmask_b32 v110, 0, v44, s[66:67]
    v_cndmask_b32 v110, v110, -1, s[64:65]
    v_cndmask_b32 v111, 0, v44, s[70:71]
    v_cndmask_b32 v111, v111, -1, s[68:69]
    s_waitcnt lgkmcnt(6)
    v_mfma_f32_32x32x16_bf16 v[48:63], v[36:39], v[176:179], v[48:63]
    v_smfmac_f32_16x16x64_bf16 v[12:15], v[8:11], v[32:39], v16
    s_waitcnt vmcnt(16)
    s_barrier
    ds_read_b64_tr_b16 v[32:33], v1 offset:0
    ds_read_b64_tr_b16 v[34:35], v1 offset:512
    buffer_load_dwordx4 v[152:155], v0, s[20:23], s99 offen offset:2048 sc1
    v_cndmask_b32 v112, 0, v44, s[74:75]
    v_cndmask_b32 v112, v112, -1, s[72:73]
    v_cndmask_b32 v113, 0, v44, s[78:79]
    v_cndmask_b32 v113, v113, -1, s[76:77]
    s_waitcnt lgkmcnt(6)
    v_mfma_f32_32x32x16_bf16 v[48:63], v[20:23], v[180:183], v[48:63]
    ds_read_b64_tr_b16 v[36:37], v2 offset:0
    ds_read_b64_tr_b16 v[38:39], v2 offset:512
    s_add_u32 m0, s44, 35072
    s_add_u32 s42, s42, 24576
    s_cmp_eq_u32 s42, 122880
    s_cselect_b32 s42, 0, s42
    buffer_load_dwordx4 v5, s[20:23], s42 offen sc1 lds
    v_cndmask_b32 v114, 0, v44, s[82:83]
    v_cndmask_b32 v114, v114, -1, s[80:81]
    v_cndmask_b32 v115, 0, v44, s[86:87]
    v_cndmask_b32 v115, v115, -1, s[84:85]
    s_waitcnt lgkmcnt(6)
    v_mfma_f32_32x32x16_bf16 v[48:63], v[24:27], v[184:187], v[48:63]
    ds_read_b64_tr_b16 v[20:21], v3 offset:0
    ds_read_b64_tr_b16 v[22:23], v3 offset:512
    buffer_load_dwordx4 v[156:159], v0, s[20:23], s99 offen offset:3072 sc1
    s_waitcnt lgkmcnt(6)
    v_mfma_f32_32x32x16_bf16 v[48:63], v[28:31], v[188:191], v[48:63]
    ds_read_b64_tr_b16 v[24:25], v4 offset:0
    ds_read_b64_tr_b16 v[26:27], v4 offset:512
    s_add_u32 m0, s44, 42272
    s_nop 0
    buffer_load_dwordx4 v5, s[20:23], s42 offen offset:1024 sc1 lds
    s_waitcnt lgkmcnt(6)
    v_mfma_f32_32x32x16_bf16 v[80:95], v[32:35], v[192:195], v[80:95]
    ds_read_b64_tr_b16 v[28:29], v1 offset:32
    ds_read_b64_tr_b16 v[30:31], v1 offset:544
    s_add_u32 s99, s31, 69632
    buffer_load_dwordx4 v[160:163], v0, s[20:23], s99 offen offset:0 sc1
    s_waitcnt lgkmcnt(6)
    v_mfma_f32_32x32x16_bf16 v[80:95], v[36:39], v[196:199], v[80:95]
    ds_read_b64_tr_b16 v[32:33], v2 offset:32
    ds_read_b64_tr_b16 v[34:35], v2 offset:544
    buffer_load_dwordx4 v[164:167], v0, s[20:23], s99 offen offset:1024 sc1
    s_waitcnt lgkmcnt(6)
    v_mfma_f32_32x32x16_bf16 v[80:95], v[20:23], v[200:203], v[80:95]
    ds_read_b64_tr_b16 v[36:37], v3 offset:32
    ds_read_b64_tr_b16 v[38:39], v3 offset:544
    buffer_load_dwordx4 v[168:171], v0, s[20:23], s99 offen offset:2048 sc1
    s_waitcnt lgkmcnt(6)
    v_mfma_f32_32x32x16_bf16 v[80:95], v[24:27], v[204:207], v[80:95]
    ds_read_b64_tr_b16 v[20:21], v4 offset:32
    ds_read_b64_tr_b16 v[22:23], v4 offset:544
    buffer_load_dwordx4 v[172:175], v0, s[20:23], s99 offen offset:3072 sc1
    s_waitcnt lgkmcnt(6)
    v_mfma_f32_32x32x16_bf16 v[48:63], v[28:31], v[192:195], v[48:63]
    v_smfmac_f32_16x16x64_bf16 v[12:15], v[8:11], v[24:31], v16
    s_waitcnt vmcnt(20)
    s_barrier
    v_add_u32 v1, -66048, v1
    ds_read_b64_tr_b16 v[24:25], v1 offset:49536
    ds_read_b64_tr_b16 v[26:27], v1 offset:50048
    s_add_u32 s99, s31, 73728
    buffer_load_dwordx4 v[176:179], v0, s[20:23], s99 offen offset:0 sc1
    s_waitcnt lgkmcnt(6)
    v_mfma_f32_32x32x16_bf16 v[48:63], v[32:35], v[196:199], v[48:63]
    ds_read_b64_tr_b16 v[28:29], v1 offset:49568
    ds_read_b64_tr_b16 v[30:31], v1 offset:50080
    s_waitcnt lgkmcnt(6)
    v_mfma_f32_32x32x16_bf16 v[48:63], v[36:39], v[200:203], v[48:63]
    v_add_u32 v2, -66048, v2
    ds_read_b64_tr_b16 v[32:33], v2 offset:49536
    ds_read_b64_tr_b16 v[34:35], v2 offset:50048
    buffer_load_dwordx4 v[180:183], v0, s[20:23], s99 offen offset:1024 sc1
    s_waitcnt lgkmcnt(6)
    v_mfma_f32_32x32x16_bf16 v[48:63], v[20:23], v[204:207], v[48:63]
    v_add_u32 v3, -66048, v3
    ds_read_b64_tr_b16 v[36:37], v3 offset:49536
    ds_read_b64_tr_b16 v[38:39], v3 offset:50048
    s_waitcnt lgkmcnt(6)
    v_mfma_f32_32x32x16_bf16 v[80:95], v[24:27], v[208:211], v[80:95]
    v_add_u32 v4, -66048, v4
    ds_read_b64_tr_b16 v[20:21], v4 offset:49536
    ds_read_b64_tr_b16 v[22:23], v4 offset:50048
    buffer_load_dwordx4 v[184:187], v0, s[20:23], s99 offen offset:2048 sc1
    s_waitcnt lgkmcnt(6)
    v_mfma_f32_32x32x16_bf16 v[48:63], v[28:31], v[208:211], v[48:63]
    v_smfmac_f32_16x16x64_bf16 v[12:15], v[8:11], v[24:31], v16
    ds_read_b64_tr_b16 v[24:25], v2 offset:49568
    ds_read_b64_tr_b16 v[26:27], v2 offset:50080
    buffer_load_dwordx4 v[188:191], v0, s[20:23], s99 offen offset:3072 sc1
    s_waitcnt lgkmcnt(6)
    v_mfma_f32_32x32x16_bf16 v[80:95], v[32:35], v[212:215], v[80:95]
    ds_read_b64_tr_b16 v[28:29], v3 offset:49568
    ds_read_b64_tr_b16 v[30:31], v3 offset:50080
    s_mul_i32 s0, s39, 40
    v_bfe_u32 v74, v0, 4, 1
    s_lshl_b32 s35, s38, 11
    v_mad_u32_u24 v75, v74, 39, s0
    s_add_u32 s35, s35, 21848064
    v_and_b32 v75, 0xffffff80, v75
    buffer_load_dword v74, v75, s[20:23], s35 offen offset:8 sc1
    s_add_u32 s99, s31, 77824
    buffer_load_dwordx4 v[192:195], v0, s[20:23], s99 offen offset:0 sc1
    s_waitcnt lgkmcnt(6)
    v_mfma_f32_32x32x16_bf16 v[80:95], v[36:39], v[216:219], v[80:95]
    ds_read_b64_tr_b16 v[32:33], v4 offset:49568
    ds_read_b64_tr_b16 v[34:35], v4 offset:50080
    buffer_load_dwordx4 v[196:199], v0, s[20:23], s99 offen offset:1024 sc1
    s_waitcnt lgkmcnt(6)
    v_mfma_f32_32x32x16_bf16 v[80:95], v[20:23], v[220:223], v[80:95]
    s_waitcnt vmcnt(25)
    s_barrier
    ds_read_b64_tr_b16 v[36:37], v1 offset:16512
    ds_read_b64_tr_b16 v[38:39], v1 offset:17024
    buffer_load_dwordx4 v[200:203], v0, s[20:23], s99 offen offset:2048 sc1
    s_waitcnt lgkmcnt(6)
    v_mfma_f32_32x32x16_bf16 v[48:63], v[24:27], v[212:215], v[48:63]
    ds_read_b64_tr_b16 v[20:21], v2 offset:16512
    ds_read_b64_tr_b16 v[22:23], v2 offset:17024
    s_add_u32 m0, s44, 68096
    s_add_u32 s42, s42, 24576
    s_cmp_eq_u32 s42, 122880
    s_cselect_b32 s42, 0, s42
    buffer_load_dwordx4 v5, s[20:23], s42 offen sc1 lds
    s_waitcnt lgkmcnt(6)
    v_mfma_f32_32x32x16_bf16 v[48:63], v[28:31], v[216:219], v[48:63]
    ds_read_b64_tr_b16 v[24:25], v3 offset:16512
    ds_read_b64_tr_b16 v[26:27], v3 offset:17024
    buffer_load_dwordx4 v[204:207], v0, s[20:23], s99 offen offset:3072 sc1
    s_waitcnt lgkmcnt(6)
    v_mfma_f32_32x32x16_bf16 v[48:63], v[32:35], v[220:223], v[48:63]
    ds_read_b64_tr_b16 v[28:29], v4 offset:16512
    ds_read_b64_tr_b16 v[30:31], v4 offset:17024
    s_add_u32 m0, s44, 75296
    s_nop 0
    buffer_load_dwordx4 v5, s[20:23], s42 offen offset:1024 sc1 lds
    s_waitcnt lgkmcnt(6)
    v_mfma_f32_32x32x16_bf16 v[80:95], v[36:39], v[224:227], v[80:95]
    ds_read_b64_tr_b16 v[32:33], v1 offset:16544
    ds_read_b64_tr_b16 v[34:35], v1 offset:17056
    s_waitcnt lgkmcnt(6)
    v_mfma_f32_32x32x16_bf16 v[80:95], v[20:23], v[228:231], v[80:95]
    ds_read_b64_tr_b16 v[36:37], v2 offset:16544
    ds_read_b64_tr_b16 v[38:39], v2 offset:17056
    s_waitcnt lgkmcnt(6)
    v_mfma_f32_32x32x16_bf16 v[80:95], v[24:27], v[232:235], v[80:95]
    ds_read_b64_tr_b16 v[20:21], v3 offset:16544
    ds_read_b64_tr_b16 v[22:23], v3 offset:17056
    s_waitcnt vmcnt(6)
    v_cmp_ne_u32 s[0:1], s45, v74
    s_cmp_lg_u64 s[0:1], 0
    s_cbranch_scc1 Lfl_100002_e
Lfd_100001:
    s_mul_i32 s0, s46, 7680
    s_mul_i32 s1, s39, 491648
    v_and_b32 v41, 0x1f0, v0
    s_add_u32 s96, s0, s1
    buffer_load_dwordx4 v[96:99], v0, s[20:23], s96 offen sc1
    s_waitcnt lgkmcnt(6)
    v_mfma_f32_32x32x16_bf16 v[80:95], v[28:31], v[236:239], v[80:95]
    ds_read_b64_tr_b16 v[24:25], v4 offset:16544
    ds_read_b64_tr_b16 v[26:27], v4 offset:17056
    buffer_load_dwordx4 v[104:107], v41, s[20:23], s96 offen offset:1024 sc1
    s_waitcnt lgkmcnt(6)
    v_mfma_f32_32x32x16_bf16 v[48:63], v[32:35], v[224:227], v[48:63]
    v_smfmac_f32_16x16x64_bf16 v[12:15], v[8:11], v[28:35], v16
    s_barrier
    ds_read_b64_tr_b16 v[28:29], v1 offset:0
    ds_read_b64_tr_b16 v[30:31], v1 offset:512
    buffer_load_dwordx4 v[100:103], v0, s[20:23], s96 offen offset:1536 sc1
    s_waitcnt lgkmcnt(6)
    v_mfma_f32_32x32x16_bf16 v[48:63], v[36:39], v[228:231], v[48:63]
    ds_read_b64_tr_b16 v[32:33], v1 offset:32
    ds_read_b64_tr_b16 v[34:35], v1 offset:544
    s_add_u32 m0, s44, 51584
    s_add_u32 s42, s42, 24576
    s_cmp_eq_u32 s42, 122880
    s_cselect_b32 s42, 0, s42
    buffer_load_dwordx4 v5, s[20:23], s42 offen sc1 lds
    s_waitcnt lgkmcnt(6)
    v_mfma_f32_32x32x16_bf16 v[48:63], v[20:23], v[232:235], v[48:63]
    ds_read_b64_tr_b16 v[36:37], v2 offset:0
    ds_read_b64_tr_b16 v[38:39], v2 offset:512
    s_waitcnt lgkmcnt(6)
    v_mfma_f32_32x32x16_bf16 v[48:63], v[24:27], v[236:239], v[48:63]
    s_waitcnt lgkmcnt(2)
    v_smfmac_f32_16x16x64_bf16 v[12:15], v[8:11], v[28:35], v16
    ds_read_b64_tr_b16 v[20:21], v3 offset:0
    ds_read_b64_tr_b16 v[22:23], v3 offset:512
    s_add_u32 m0, s44, 58784
    s_nop 0
    buffer_load_dwordx4 v5, s[20:23], s42 offen offset:1024 sc1 lds
    v_mfma_f32_32x32x16_bf16 v[80:95], v[28:31], v[240:243], v[80:95]
    ds_read_b64_tr_b16 v[24:25], v4 offset:0
    ds_read_b64_tr_b16 v[26:27], v4 offset:512
    s_lshl_b32 s0, s37, 10
    v_add_f32 v12, v12, v13
    v_add_u32 v17, s0, v0
    v_lshl_add_u32 v13, s36, 2, v17
    ds_write_b32 v13, v12 offset:0
    v_mfma_f32_32x32x16_bf16 v[48:63], v[32:35], v[240:243], v[48:63]
    ds_read_b64_tr_b16 v[28:29], v2 offset:32
    ds_read_b64_tr_b16 v[30:31], v2 offset:544
    s_waitcnt lgkmcnt(7)
    v_mfma_f32_32x32x16_bf16 v[80:95], v[36:39], v[244:247], v[80:95]
    ds_read_b64_tr_b16 v[32:33], v3 offset:32
    ds_read_b64_tr_b16 v[34:35], v3 offset:544
    s_waitcnt lgkmcnt(7)
    v_mfma_f32_32x32x16_bf16 v[80:95], v[20:23], v[248:251], v[80:95]
    ds_read_b64_tr_b16 v[36:37], v4 offset:32
    ds_read_b64_tr_b16 v[38:39], v4 offset:544
    s_waitcnt lgkmcnt(7)
    v_mfma_f32_32x32x16_bf16 v[80:95], v[24:27], v[252:255], v[80:95]
    s_waitcnt lgkmcnt(6)
    s_barrier
    ds_read_b128 v[12:15], v17 offset:0
    s_waitcnt lgkmcnt(5)
    v_mfma_f32_32x32x16_bf16 v[48:63], v[28:31], v[244:247], v[48:63]
    s_waitcnt lgkmcnt(0)
    v_add_f32 v12, v12, v13
    v_add_f32 v14, v14, v15
    v_mov_b32 v17, 0
    v_add_f32 v12, v12, v14
    v_mov_b32 v18, 0
    v_cvt_pk_bf16_f32 v13, v12, v12
    v_and_b32 v13, 0xffff0000, v13
    v_sub_f32 v12, v12, v13
    v_cvt_pk_bf16_f32 v16, v13, v12
    v_cvt_pk_bf16_f32 v19, v13, v12
    v_mfma_f32_32x32x16_bf16 v[48:63], v[32:35], v[248:251], v[48:63]
    v_mfma_f32_32x32x8_bf16 v[80:95], v[16:17], v[6:7], v[80:95]
    v_mfma_f32_32x32x16_bf16 v[48:63], v[36:39], v[252:255], v[48:63]
    v_mfma_f32_32x32x8_bf16 v[48:63], v[18:19], v[6:7], v[48:63]
    s_setprio 2
    s_nop 8
    v_max_f32 v80, 0, v80
    v_mul_f32 v88, v40, v88
    v_max_f32 v81, 0, v81
    v_mul_f32 v89, v40, v89
    v_mul_f32 v80, v80, v88
    v_mul_f32 v81, v81, v89
    v_cvt_pk_bf16_f32 v80, v80, v81
    v_max_f32 v82, 0, v82
    v_mul_f32 v90, v40, v90
    v_max_f32 v83, 0, v83
    v_mul_f32 v91, v40, v91
    v_mul_f32 v82, v82, v90
    v_mul_f32 v83, v83, v91
    v_cvt_pk_bf16_f32 v81, v82, v83
    v_max_f32 v84, 0, v84
    v_mul_f32 v92, v40, v92
    v_max_f32 v85, 0, v85
    v_mul_f32 v93, v40, v93
    v_mul_f32 v84, v84, v92
    v_mul_f32 v85, v85, v93
    v_cvt_pk_bf16_f32 v82, v84, v85
    v_max_f32 v86, 0, v86
    v_mul_f32 v94, v40, v94
    v_max_f32 v87, 0, v87
    v_mul_f32 v95, v40, v95
    v_mul_f32 v86, v86, v94
    v_mul_f32 v87, v87, v95
    v_cvt_pk_bf16_f32 v83, v86, v87
    buffer_store_dwordx4 v[80:83], v0, s[20:23], s32 offen offset:0 sc1
    v_max_f32 v48, 0, v48
    v_mul_f32 v56, v40, v56
    v_max_f32 v49, 0, v49
    v_mul_f32 v57, v40, v57
    v_mul_f32 v48, v48, v56
    v_mul_f32 v49, v49, v57
    v_cvt_pk_bf16_f32 v48, v48, v49
    v_max_f32 v50, 0, v50
    v_mul_f32 v58, v40, v58
    v_max_f32 v51, 0, v51
    v_mul_f32 v59, v40, v59
    v_mul_f32 v50, v50, v58
    v_mul_f32 v51, v51, v59
    v_cvt_pk_bf16_f32 v49, v50, v51
    v_max_f32 v52, 0, v52
    v_mul_f32 v60, v40, v60
    v_max_f32 v53, 0, v53
    v_mul_f32 v61, v40, v61
    v_mul_f32 v52, v52, v60
    v_mul_f32 v53, v53, v61
    v_cvt_pk_bf16_f32 v50, v52, v53
    v_max_f32 v54, 0, v54
    v_mul_f32 v62, v40, v62
    v_max_f32 v55, 0, v55
    v_mul_f32 v63, v40, v63
    v_mul_f32 v54, v54, v62
    v_mul_f32 v55, v55, v63
    v_cvt_pk_bf16_f32 v51, v54, v55
    buffer_store_dwordx4 v[48:51], v0, s[20:23], s32 offen offset:1024 sc1
    s_waitcnt vmcnt(2)
    s_barrier
    ds_read_b128 v[48:51], v124 offset:41216
    ds_read_b64 v[42:43], v126 offset:41216
    ds_read_b128 v[52:55], v124 offset:0
    ds_read_b64 v[44:45], v126 offset:0
    ds_read_b128 v[56:59], v124 offset:5152
    ds_read_b64 v[46:47], v126 offset:5152
    ds_read_b64_tr_b16 v[240:241], v116 offset:0
    ds_read_b64_tr_b16 v[242:243], v117 offset:0
    ds_read_b64_tr_b16 v[244:245], v118 offset:0
    ds_read_b64_tr_b16 v[246:247], v119 offset:0
    ds_read_b64_tr_b16 v[248:249], v116 offset:41216
    ds_read_b64_tr_b16 v[250:251], v117 offset:41216
    ds_read_b64_tr_b16 v[252:253], v118 offset:41216
    ds_read_b64_tr_b16 v[254:255], v119 offset:41216
    s_waitcnt lgkmcnt(13)
    v_mfma_f32_32x32x16_bf16 v[8:23], v[48:51], v[96:99], 0
    s_waitcnt lgkmcnt(11)
    v_mfma_f32_32x32x16_bf16 v[24:39], v[52:55], v[96:99], 0
    s_nop 9
    v_max3_f32 v1, v8, v9, v10
    v_max3_f32 v2, v11, v12, v13
    v_max3_f32 v2, v14, v15, v2
    v_max3_f32 v1, v16, v17, v1
    v_max3_f32 v2, v18, v19, v2
    v_max3_f32 v1, v20, v21, v1
    v_max3_f32 v2, v22, v23, v2
    v_max_f32 v1, v1, v2
    v_mov_b32 v2, v1
    s_nop 1
    v_permlane32_swap_b32 v2, v1
    v_max_f32 v1, v1, v2
    v_cvt_pk_bf16_f32 v1, 1.0, -v1
    v_cndmask_b32 v104, v104, v1, s[90:91]
    s_nop 1
    v_mfma_f32_32x32x8_bf16 v[8:23], v[42:43], v[104:105], v[8:23]
    ds_read_b128 v[48:51], v124 offset:10304
    ds_read_b64 v[42:43], v126 offset:10304
    s_waitcnt lgkmcnt(12)
    v_mfma_f32_32x32x8_bf16 v[24:39], v[44:45], v[104:105], v[24:39]
    ds_read_b128 v[52:55], v124 offset:15456
    ds_read_b64 v[44:45], v126 offset:15456
    s_waitcnt lgkmcnt(13)
    v_mfma_f32_32x32x16_bf16 v[80:95], v[56:59], v[96:99], 0
    s_nop 7
    v_cndmask_b32 v8, v8, v24, s[56:57]
    v_cndmask_b32 v9, v9, v25, s[58:59]
    v_cndmask_b32 v10, v10, v26, s[60:61]
    v_cndmask_b32 v11, v11, v27, s[62:63]
    v_cndmask_b32 v12, v12, v28, s[64:65]
    v_cndmask_b32 v13, v13, v29, s[66:67]
    v_cndmask_b32 v14, v14, v30, s[68:69]
    v_cndmask_b32 v15, v15, v31, s[70:71]
    v_cndmask_b32 v16, v16, v32, s[72:73]
    v_cndmask_b32 v17, v17, v33, s[74:75]
    v_cndmask_b32 v18, v18, v34, s[76:77]
    v_cndmask_b32 v19, v19, v35, s[78:79]
    v_cndmask_b32 v20, v20, v36, s[80:81]
    v_cndmask_b32 v21, v21, v37, s[82:83]
    v_cndmask_b32 v22, v22, v38, s[84:85]
    v_cndmask_b32 v23, v23, v39, s[86:87]
    s_waitcnt vmcnt(0)
    v_mov_b32 v6, s45
    s_mov_b64 exec, 0xff
    buffer_store_dwordx4 v[4:7], v0, s[20:23], s28 offen sc1
    s_mov_b64 exec, -1
    v_exp_f32 v8, v8
    v_exp_f32 v9, v9
    v_exp_f32 v10, v10
    v_exp_f32 v11, v11
    v_cvt_pk_bf16_f32 v224, v8, v9
    s_waitcnt lgkmcnt(12)
    v_mfma_f32_32x32x8_bf16 v[80:95], v[46:47], v[104:105], v[80:95]
    ds_read_b128 v[56:59], v124 offset:20608
    ds_read_b64 v[46:47], v126 offset:20608
    v_exp_f32 v12, v12
    v_exp_f32 v13, v13
    v_cvt_pk_bf16_f32 v225, v10, v11
    v_exp_f32 v14, v14
    v_exp_f32 v15, v15
    v_cvt_pk_bf16_f32 v226, v12, v13
    v_exp_f32 v16, v16
    v_exp_f32 v17, v17
    v_cvt_pk_bf16_f32 v227, v14, v15
    v_exp_f32 v18, v18
    v_bfi_b32 v232, v108, 0, v224
    v_and_b32 v224, v108, v224
    v_bfi_b32 v233, v109, 0, v225
    v_and_b32 v225, v109, v225
    v_bfi_b32 v234, v110, 0, v226
    v_and_b32 v226, v110, v226
    v_bfi_b32 v235, v111, 0, v227
    v_and_b32 v227, v111, v227
    v_exp_f32 v19, v19
    v_cvt_pk_bf16_f32 v228, v16, v17
    v_exp_f32 v20, v20
    v_exp_f32 v21, v21
    v_cvt_pk_bf16_f32 v229, v18, v19
    v_exp_f32 v22, v22
    v_exp_f32 v23, v23
    v_cvt_pk_bf16_f32 v230, v20, v21
    s_waitcnt lgkmcnt(12)
    v_mfma_f32_32x32x16_bf16 v[208:223], v[240:243], v[224:227], 0
    v_cvt_pk_bf16_f32 v231, v22, v23
    v_bfi_b32 v236, v112, 0, v228
    v_and_b32 v228, v112, v228
    v_bfi_b32 v237, v113, 0, v229
    v_and_b32 v229, v113, v229
    v_bfi_b32 v238, v114, 0, v230
    v_and_b32 v230, v114, v230
    v_bfi_b32 v239, v115, 0, v231
    v_and_b32 v231, v115, v231
    s_waitcnt lgkmcnt(8)
    v_mfma_f32_32x32x16_bf16 v[208:223], v[248:251], v[232:235], v[208:223]
    v_exp_f32 v80, v80
    v_exp_f32 v81, v81
    v_exp_f32 v82, v82
    s_waitcnt lgkmcnt(6)
    v_mfma_f32_32x32x16_bf16 v[208:223], v[252:255], v[236:239], v[208:223]
    ds_read_b64_tr_b16 v[248:249], v116 offset:5152
    ds_read_b64_tr_b16 v[250:251], v117 offset:5152
    ds_read_b64_tr_b16 v[252:253], v118 offset:5152
    ds_read_b64_tr_b16 v[254:255], v119 offset:5152
    v_exp_f32 v83, v83
    v_cvt_pk_bf16_f32 v232, v80, v81
    v_exp_f32 v84, v84
    v_exp_f32 v85, v85
    v_cvt_pk_bf16_f32 v233, v82, v83
    s_waitcnt lgkmcnt(9)
    v_mfma_f32_32x32x16_bf16 v[8:23], v[48:51], v[96:99], 0
    v_exp_f32 v86, v86
    v_exp_f32 v87, v87
    v_cvt_pk_bf16_f32 v234, v84, v85
    v_exp_f32 v88, v88
    v_exp_f32 v89, v89
    v_cvt_pk_bf16_f32 v235, v86, v87
    s_waitcnt lgkmcnt(8)
    v_mfma_f32_32x32x8_bf16 v[8:23], v[42:43], v[104:105], v[8:23]
    ds_read_b128 v[48:51], v124 offset:25760
    ds_read_b64 v[42:43], v126 offset:25760
    v_exp_f32 v90, v90
    v_exp_f32 v91, v91
    v_cvt_pk_bf16_f32 v236, v88, v89
    v_exp_f32 v92, v92
    v_mfma_f32_32x32x16_bf16 v[208:223], v[244:247], v[228:231], v[208:223]
    ds_read_b64_tr_b16 v[240:241], v116 offset:10304
    ds_read_b64_tr_b16 v[242:243], v117 offset:10304
    ds_read_b64_tr_b16 v[244:245], v118 offset:10304
    ds_read_b64_tr_b16 v[246:247], v119 offset:10304
    v_exp_f32 v93, v93
    v_cvt_pk_bf16_f32 v237, v90, v91
    v_exp_f32 v94, v94
    v_exp_f32 v95, v95
    v_cvt_pk_bf16_f32 v238, v92, v93
    s_waitcnt lgkmcnt(8)
    v_mfma_f32_32x32x16_bf16 v[208:223], v[248:251], v[232:235], v[208:223]
    v_cvt_pk_bf16_f32 v239, v94, v95
    v_exp_f32 v8, v8
    v_exp_f32 v9, v9
    v_exp_f32 v10, v10
    v_exp_f32 v11, v11
    v_cvt_pk_bf16_f32 v224, v8, v9
    v_mfma_f32_32x32x16_bf16 v[80:95], v[52:55], v[96:99], 0
    v_exp_f32 v12, v12
    v_exp_f32 v13, v13
    v_cvt_pk_bf16_f32 v225, v10, v11
    v_exp_f32 v14, v14
    v_exp_f32 v15, v15
    v_cvt_pk_bf16_f32 v226, v12, v13
    v_mfma_f32_32x32x8_bf16 v[80:95], v[44:45], v[104:105], v[80:95]
    ds_read_b128 v[52:55], v124 offset:30912
    ds_read_b64 v[44:45], v126 offset:30912
    v_exp_f32 v16, v16
    v_exp_f32 v17, v17
    v_cvt_pk_bf16_f32 v227, v14, v15
    v_exp_f32 v18, v18
    v_exp_f32 v19, v19
    v_cvt_pk_bf16_f32 v228, v16, v17
    s_waitcnt lgkmcnt(8)
    v_mfma_f32_32x32x16_bf16 v[208:223], v[252:255], v[236:239], v[208:223]
    ds_read_b64_tr_b16 v[248:249], v116 offset:15456
    ds_read_b64_tr_b16 v[250:251], v117 offset:15456
    ds_read_b64_tr_b16 v[252:253], v118 offset:15456
    ds_read_b64_tr_b16 v[254:255], v119 offset:15456
    v_exp_f32 v20, v20
    v_exp_f32 v21, v21
    v_cvt_pk_bf16_f32 v229, v18, v19
    v_exp_f32 v22, v22
    v_exp_f32 v23, v23
    v_cvt_pk_bf16_f32 v230, v20, v21
    s_waitcnt lgkmcnt(8)
    v_mfma_f32_32x32x16_bf16 v[208:223], v[240:243], v[224:227], v[208:223]
    v_cvt_pk_bf16_f32 v231, v22, v23
    v_exp_f32 v80, v80
    v_exp_f32 v81, v81
    v_exp_f32 v82, v82
    v_exp_f32 v83, v83
    v_cvt_pk_bf16_f32 v232, v80, v81
    v_mfma_f32_32x32x16_bf16 v[8:23], v[56:59], v[96:99], 0
    v_exp_f32 v84, v84
    v_exp_f32 v85, v85
    v_cvt_pk_bf16_f32 v233, v82, v83
    v_exp_f32 v86, v86
    v_exp_f32 v87, v87
    v_cvt_pk_bf16_f32 v234, v84, v85
    v_mfma_f32_32x32x8_bf16 v[8:23], v[46:47], v[104:105], v[8:23]
    ds_read_b128 v[56:59], v125 offset:41216
    ds_read_b64 v[46:47], v127 offset:41216
    v_exp_f32 v88, v88
    v_exp_f32 v89, v89
    v_cvt_pk_bf16_f32 v235, v86, v87
    v_exp_f32 v90, v90
    v_exp_f32 v91, v91
    v_cvt_pk_bf16_f32 v236, v88, v89
    s_waitcnt lgkmcnt(8)
    v_mfma_f32_32x32x16_bf16 v[208:223], v[244:247], v[228:231], v[208:223]
    ds_read_b64_tr_b16 v[240:241], v116 offset:20608
    ds_read_b64_tr_b16 v[242:243], v117 offset:20608
    ds_read_b64_tr_b16 v[244:245], v118 offset:20608
    ds_read_b64_tr_b16 v[246:247], v119 offset:20608
    v_exp_f32 v92, v92
    v_exp_f32 v93, v93
    v_cvt_pk_bf16_f32 v237, v90, v91
    v_exp_f32 v94, v94
    v_exp_f32 v95, v95
    v_cvt_pk_bf16_f32 v238, v92, v93
    s_waitcnt lgkmcnt(8)
    v_mfma_f32_32x32x16_bf16 v[208:223], v[248:251], v[232:235], v[208:223]
    v_cvt_pk_bf16_f32 v239, v94, v95
    v_exp_f32 v8, v8
    v_exp_f32 v9, v9
    v_exp_f32 v10, v10
    v_exp_f32 v11, v11
    v_cvt_pk_bf16_f32 v224, v8, v9
    v_mfma_f32_32x32x16_bf16 v[80:95], v[48:51], v[96:99], 0
    v_exp_f32 v12, v12
    v_exp_f32 v13, v13
    v_cvt_pk_bf16_f32 v225, v10, v11
    v_exp_f32 v14, v14
    v_exp_f32 v15, v15
    v_cvt_pk_bf16_f32 v226, v12, v13
    v_mfma_f32_32x32x8_bf16 v[80:95], v[42:43], v[104:105], v[80:95]
    ds_read_b128 v[48:51], v124 offset:36064
    ds_read_b64 v[42:43], v126 offset:36064
    v_exp_f32 v16, v16
    v_exp_f32 v17, v17
    v_cvt_pk_bf16_f32 v227, v14, v15
    v_exp_f32 v18, v18
    v_exp_f32 v19, v19
    v_cvt_pk_bf16_f32 v228, v16, v17
    s_waitcnt lgkmcnt(8)
    v_mfma_f32_32x32x16_bf16 v[208:223], v[252:255], v[236:239], v[208:223]
    ds_read_b64_tr_b16 v[248:249], v116 offset:25760
    ds_read_b64_tr_b16 v[250:251], v117 offset:25760
    ds_read_b64_tr_b16 v[252:253], v118 offset:25760
    ds_read_b64_tr_b16 v[254:255], v119 offset:25760
    v_exp_f32 v20, v20
    v_exp_f32 v21, v21
    v_cvt_pk_bf16_f32 v229, v18, v19
    v_exp_f32 v22, v22
    v_exp_f32 v23, v23
    v_cvt_pk_bf16_f32 v230, v20, v21
    s_waitcnt lgkmcnt(8)
    v_mfma_f32_32x32x16_bf16 v[208:223], v[240:243], v[224:227], v[208:223]
    v_cvt_pk_bf16_f32 v231, v22, v23
    v_exp_f32 v80, v80
    v_exp_f32 v81, v81
    v_exp_f32 v82, v82
    v_mfma_f32_32x32x16_bf16 v[8:23], v[52:55], v[96:99], 0
    v_exp_f32 v83, v83
    v_cvt_pk_bf16_f32 v232, v80, v81
    v_exp_f32 v84, v84
    v_exp_f32 v85, v85
    v_cvt_pk_bf16_f32 v233, v82, v83
    v_mfma_f32_32x32x8_bf16 v[8:23], v[44:45], v[104:105], v[8:23]
    ds_read_b128 v[52:55], v125 offset:0
    ds_read_b64 v[44:45], v127 offset:0
    v_exp_f32 v86, v86
    v_exp_f32 v87, v87
    v_cvt_pk_bf16_f32 v234, v84, v85
    v_exp_f32 v88, v88
    v_mfma_f32_32x32x16_bf16 v[24:39], v[56:59], v[100:103], 0
    v_exp_f32 v89, v89
    v_cvt_pk_bf16_f32 v235, v86, v87
    v_exp_f32 v90, v90
    v_exp_f32 v91, v91
    v_cvt_pk_bf16_f32 v236, v88, v89
    v_exp_f32 v92, v92
    s_waitcnt lgkmcnt(8)
    v_mfma_f32_32x32x16_bf16 v[208:223], v[244:247], v[228:231], v[208:223]
    ds_read_b64_tr_b16 v[240:241], v116 offset:30912
    ds_read_b64_tr_b16 v[242:243], v117 offset:30912
    ds_read_b64_tr_b16 v[244:245], v118 offset:30912
    ds_read_b64_tr_b16 v[246:247], v119 offset:30912
    v_exp_f32 v93, v93
    v_cvt_pk_bf16_f32 v237, v90, v91
    v_exp_f32 v94, v94
    v_exp_f32 v95, v95
    v_cvt_pk_bf16_f32 v238, v92, v93
    s_waitcnt lgkmcnt(8)
    v_mfma_f32_32x32x16_bf16 v[208:223], v[248:251], v[232:235], v[208:223]
    v_cvt_pk_bf16_f32 v239, v94, v95
    v_exp_f32 v8, v8
    v_max3_f32 v1, v24, v25, v26
    v_max3_f32 v2, v27, v28, v29
    v_max3_f32 v2, v30, v31, v2
    v_max3_f32 v1, v32, v33, v1
    v_max3_f32 v2, v34, v35, v2
    v_exp_f32 v9, v9
    v_exp_f32 v10, v10
    v_mfma_f32_32x32x16_bf16 v[80:95], v[48:51], v[96:99], 0
    v_max3_f32 v1, v36, v37, v1
    v_max3_f32 v2, v38, v39, v2
    v_max_f32 v1, v1, v2
    v_mov_b32 v2, v1
    v_exp_f32 v11, v11
    v_cvt_pk_bf16_f32 v224, v8, v9
    v_exp_f32 v12, v12
    v_permlane32_swap_b32 v2, v1
    v_max_f32 v1, v1, v2
    v_cvt_pk_bf16_f32 v1, 1.0, -v1
    v_cndmask_b32 v106, v106, v1, s[90:91]
    v_exp_f32 v13, v13
    v_cvt_pk_bf16_f32 v225, v10, v11
    v_mfma_f32_32x32x8_bf16 v[80:95], v[42:43], v[104:105], v[80:95]
    ds_read_b128 v[48:51], v125 offset:5152
    ds_read_b64 v[42:43], v127 offset:5152
    v_exp_f32 v14, v14
    v_exp_f32 v15, v15
    v_cvt_pk_bf16_f32 v226, v12, v13
    v_exp_f32 v16, v16
    s_waitcnt lgkmcnt(8)
    v_mfma_f32_32x32x16_bf16 v[208:223], v[252:255], v[236:239], v[208:223]
    ds_read_b64_tr_b16 v[248:249], v116 offset:36064
    ds_read_b64_tr_b16 v[250:251], v117 offset:36064
    ds_read_b64_tr_b16 v[252:253], v118 offset:36064
    ds_read_b64_tr_b16 v[254:255], v119 offset:36064
    v_exp_f32 v17, v17
    v_cvt_pk_bf16_f32 v227, v14, v15
    v_exp_f32 v18, v18
    v_exp_f32 v19, v19
    v_cvt_pk_bf16_f32 v228, v16, v17
    v_exp_f32 v20, v20
    v_mfma_f32_32x32x8_bf16 v[24:39], v[46:47], v[106:107], v[24:39]
    ds_read_b128 v[56:59], v125 offset:10304
    ds_read_b64 v[46:47], v127 offset:10304
    v_exp_f32 v21, v21
    v_cvt_pk_bf16_f32 v229, v18, v19
    v_exp_f32 v22, v22
    v_exp_f32 v23, v23
    v_cvt_pk_bf16_f32 v230, v20, v21
    s_waitcnt lgkmcnt(10)
    v_mfma_f32_32x32x16_bf16 v[208:223], v[240:243], v[224:227], v[208:223]
    v_cvt_pk_bf16_f32 v231, v22, v23
    v_exp_f32 v80, v80
    v_exp_f32 v81, v81
    v_exp_f32 v82, v82
    v_exp_f32 v83, v83
    v_cvt_pk_bf16_f32 v232, v80, v81
    v_mfma_f32_32x32x16_bf16 v[8:23], v[52:55], v[100:103], 0
    v_exp_f32 v84, v84
    v_exp_f32 v85, v85
    v_cvt_pk_bf16_f32 v233, v82, v83
    v_exp_f32 v86, v86
    v_exp_f32 v87, v87
    v_cvt_pk_bf16_f32 v234, v84, v85
    v_mfma_f32_32x32x8_bf16 v[8:23], v[44:45], v[106:107], v[8:23]
    ds_read_b128 v[52:55], v125 offset:15456
    ds_read_b64 v[44:45], v127 offset:15456
    v_exp_f32 v88, v88
    v_exp_f32 v89, v89
    v_cvt_pk_bf16_f32 v235, v86, v87
    v_exp_f32 v90, v90
    v_exp_f32 v91, v91
    v_cvt_pk_bf16_f32 v236, v88, v89
    s_waitcnt lgkmcnt(10)
    v_mfma_f32_32x32x16_bf16 v[208:223], v[244:247], v[228:231], v[208:223]
    ds_read_b64_tr_b16 v[240:241], v120 offset:0
    ds_read_b64_tr_b16 v[242:243], v121 offset:0
    ds_read_b64_tr_b16 v[244:245], v122 offset:0
    ds_read_b64_tr_b16 v[246:247], v123 offset:0
    v_exp_f32 v92, v92
    v_cndmask_b32 v24, v24, v8, s[56:57]
    v_cndmask_b32 v25, v25, v9, s[58:59]
    v_cndmask_b32 v26, v26, v10, s[60:61]
    v_cndmask_b32 v27, v27, v11, s[62:63]
    v_cndmask_b32 v28, v28, v12, s[64:65]
    v_cndmask_b32 v29, v29, v13, s[66:67]
    v_cndmask_b32 v30, v30, v14, s[68:69]
    v_cndmask_b32 v31, v31, v15, s[70:71]
    v_cndmask_b32 v32, v32, v16, s[72:73]
    v_cndmask_b32 v33, v33, v17, s[74:75]
    v_cndmask_b32 v34, v34, v18, s[76:77]
    v_cndmask_b32 v35, v35, v19, s[78:79]
    v_cndmask_b32 v36, v36, v20, s[80:81]
    v_cndmask_b32 v37, v37, v21, s[82:83]
    v_cndmask_b32 v38, v38, v22, s[84:85]
    v_cndmask_b32 v39, v39, v23, s[86:87]
    v_exp_f32 v93, v93
    v_cvt_pk_bf16_f32 v237, v90, v91
    v_exp_f32 v94, v94
    v_exp_f32 v95, v95
    v_cvt_pk_bf16_f32 v238, v92, v93
    s_waitcnt lgkmcnt(10)
    v_mfma_f32_32x32x16_bf16 v[208:223], v[248:251], v[232:235], v[208:223]
    v_cvt_pk_bf16_f32 v239, v94, v95
    v_exp_f32 v24, v24
    v_exp_f32 v25, v25
    v_exp_f32 v26, v26
    v_exp_f32 v27, v27
    v_cvt_pk_bf16_f32 v224, v24, v25
    v_mfma_f32_32x32x16_bf16 v[80:95], v[48:51], v[100:103], 0
    v_exp_f32 v28, v28
    v_exp_f32 v29, v29
    v_cvt_pk_bf16_f32 v225, v26, v27
    v_exp_f32 v30, v30
    v_exp_f32 v31, v31
    v_cvt_pk_bf16_f32 v226, v28, v29
    v_mfma_f32_32x32x8_bf16 v[80:95], v[42:43], v[106:107], v[80:95]
    ds_read_b128 v[48:51], v125 offset:20608
    ds_read_b64 v[42:43], v127 offset:20608
    v_exp_f32 v32, v32
    v_exp_f32 v33, v33
    v_cvt_pk_bf16_f32 v227, v30, v31
    v_exp_f32 v34, v34
    v_bfi_b32 v232, v108, 0, v224
    v_and_b32 v224, v108, v224
    v_bfi_b32 v233, v109, 0, v225
    v_and_b32 v225, v109, v225
    v_bfi_b32 v234, v110, 0, v226
    v_and_b32 v226, v110, v226
    v_bfi_b32 v235, v111, 0, v227
    v_and_b32 v227, v111, v227
    v_exp_f32 v35, v35
    v_cvt_pk_bf16_f32 v228, v32, v33
    s_waitcnt lgkmcnt(10)
    v_mfma_f32_32x32x16_bf16 v[208:223], v[252:255], v[236:239], v[208:223]
    ds_read_b64_tr_b16 v[248:249], v120 offset:41216
    ds_read_b64_tr_b16 v[250:251], v121 offset:41216
    ds_read_b64_tr_b16 v[252:253], v122 offset:41216
    ds_read_b64_tr_b16 v[254:255], v123 offset:41216
    v_exp_f32 v36, v36
    v_exp_f32 v37, v37
    v_cvt_pk_bf16_f32 v229, v34, v35
    v_exp_f32 v38, v38
    v_exp_f32 v39, v39
    v_cvt_pk_bf16_f32 v230, v36, v37
    s_waitcnt lgkmcnt(8)
    v_mfma_f32_32x32x16_bf16 v[64:79], v[240:243], v[224:227], 0
    v_cvt_pk_bf16_f32 v231, v38, v39
    v_bfi_b32 v236, v112, 0, v228
    v_and_b32 v228, v112, v228
    v_bfi_b32 v237, v113, 0, v229
    v_and_b32 v229, v113, v229
    v_bfi_b32 v238, v114, 0, v230
    v_and_b32 v230, v114, v230
    v_bfi_b32 v239, v115, 0, v231
    v_and_b32 v231, v115, v231
    s_waitcnt lgkmcnt(2)
    v_mfma_f32_32x32x16_bf16 v[64:79], v[248:251], v[232:235], v[64:79]
    v_exp_f32 v80, v80
    s_mov_b32 s47, 0x21800000
    s_mov_b32 s48, 0x5d800000
    v_cmp_nlt_f32 vcc, s47, v220
    v_cmp_ngt_f32 s[50:51], s48, v220
    s_or_b64 vcc, vcc, s[50:51]
    s_cmp_lg_u64 vcc, 0
    s_cselect_b32 s92, 1, 0
    s_sub_u32 s96, s95, 8192
    s_cmp_lg_u32 s92, 0
    s_cselect_b32 s97, 0x7ffffff0, s96
    v_exp_f32 v81, v81
    v_exp_f32 v82, v82
    s_waitcnt lgkmcnt(0)
    v_mfma_f32_32x32x16_bf16 v[64:79], v[252:255], v[236:239], v[64:79]
    ds_read_b64_tr_b16 v[248:249], v120 offset:5152
    ds_read_b64_tr_b16 v[250:251], v121 offset:5152
    ds_read_b64_tr_b16 v[252:253], v122 offset:5152
    ds_read_b64_tr_b16 v[254:255], v123 offset:5152
    v_rcp_f32 v3, v220
    s_nop 0
    v_mul_f32 v208, v3, v208
    v_mul_f32 v209, v3, v209
    v_mul_f32 v210, v3, v210
    v_exp_f32 v83, v83
    v_cvt_pk_bf16_f32 v232, v80, v81
    v_exp_f32 v84, v84
    v_mul_f32 v211, v3, v211
    v_mul_f32 v212, v3, v212
    v_mul_f32 v213, v3, v213
    v_mul_f32 v214, v3, v214
    v_exp_f32 v85, v85
    v_cvt_pk_bf16_f32 v233, v82, v83
    v_mfma_f32_32x32x16_bf16 v[24:39], v[56:59], v[100:103], 0
    v_exp_f32 v86, v86
    v_mul_f32 v215, v3, v215
    v_mul_f32 v216, v3, v216
    v_mul_f32 v217, v3, v217
    v_mul_f32 v218, v3, v218
    v_exp_f32 v87, v87
    v_cvt_pk_bf16_f32 v234, v84, v85
    v_exp_f32 v88, v88
    v_mul_f32 v219, v3, v219
    v_cvt_pk_bf16_f32 v208, v208, v209
    v_cvt_pk_bf16_f32 v209, v210, v211
    v_cvt_pk_bf16_f32 v210, v212, v213
    v_exp_f32 v89, v89
    v_cvt_pk_bf16_f32 v235, v86, v87
    v_mfma_f32_32x32x8_bf16 v[24:39], v[46:47], v[106:107], v[24:39]
    ds_read_b128 v[56:59], v125 offset:25760
    ds_read_b64 v[46:47], v127 offset:25760
    v_exp_f32 v90, v90
    v_cvt_pk_bf16_f32 v211, v214, v215
    v_cvt_pk_bf16_f32 v60, v216, v217
    v_cvt_pk_bf16_f32 v61, v218, v219
    v_min_u32 v208, -2, v208
    v_exp_f32 v91, v91
    v_cvt_pk_bf16_f32 v236, v88, v89
    v_exp_f32 v92, v92
    v_mfma_f32_32x32x16_bf16 v[64:79], v[244:247], v[228:231], v[64:79]
    ds_read_b64_tr_b16 v[240:241], v120 offset:10304
    ds_read_b64_tr_b16 v[242:243], v121 offset:10304
    ds_read_b64_tr_b16 v[244:245], v122 offset:10304
    ds_read_b64_tr_b16 v[246:247], v123 offset:10304
    v_min_u32 v209, -2, v209
    v_min_u32 v210, -2, v210
    v_min_u32 v211, -2, v211
    v_min_u32 v60, -2, v60
    v_exp_f32 v93, v93
    v_cvt_pk_bf16_f32 v237, v90, v91
    v_exp_f32 v94, v94
    v_min_u32 v61, -2, v61
    buffer_store_dwordx4 v[208:211], v0, s[20:23], s97 offen sc1
    v_exp_f32 v95, v95
    v_cvt_pk_bf16_f32 v238, v92, v93
    s_waitcnt lgkmcnt(8)
    v_mfma_f32_32x32x16_bf16 v[64:79], v[248:251], v[232:235], v[64:79]
    v_cvt_pk_bf16_f32 v239, v94, v95
    v_exp_f32 v24, v24
    v_exp_f32 v25, v25
    v_exp_f32 v26, v26
    v_exp_f32 v27, v27
    v_cvt_pk_bf16_f32 v224, v24, v25
    v_mfma_f32_32x32x16_bf16 v[80:95], v[52:55], v[100:103], 0
    v_exp_f32 v28, v28
    v_exp_f32 v29, v29
    v_cvt_pk_bf16_f32 v225, v26, v27
    v_exp_f32 v30, v30
    v_exp_f32 v31, v31
    v_cvt_pk_bf16_f32 v226, v28, v29
    v_mfma_f32_32x32x8_bf16 v[80:95], v[44:45], v[106:107], v[80:95]
    ds_read_b128 v[52:55], v125 offset:30912
    ds_read_b64 v[44:45], v127 offset:30912
    v_exp_f32 v32, v32
    v_exp_f32 v33, v33
    v_cvt_pk_bf16_f32 v227, v30, v31
    v_exp_f32 v34, v34
    v_exp_f32 v35, v35
    v_cvt_pk_bf16_f32 v228, v32, v33
    s_waitcnt lgkmcnt(8)
    v_mfma_f32_32x32x16_bf16 v[64:79], v[252:255], v[236:239], v[64:79]
    ds_read_b64_tr_b16 v[248:249], v120 offset:15456
    ds_read_b64_tr_b16 v[250:251], v121 offset:15456
    ds_read_b64_tr_b16 v[252:253], v122 offset:15456
    ds_read_b64_tr_b16 v[254:255], v123 offset:15456
    v_exp_f32 v36, v36
    v_exp_f32 v37, v37
    v_cvt_pk_bf16_f32 v229, v34, v35
    v_exp_f32 v38, v38
    v_exp_f32 v39, v39
    v_cvt_pk_bf16_f32 v230, v36, v37
    s_waitcnt lgkmcnt(8)
    v_mfma_f32_32x32x16_bf16 v[64:79], v[240:243], v[224:227], v[64:79]
    v_cvt_pk_bf16_f32 v231, v38, v39
    v_exp_f32 v80, v80
    v_exp_f32 v81, v81
    v_exp_f32 v82, v82
    v_exp_f32 v83, v83
    v_cvt_pk_bf16_f32 v232, v80, v81
    v_mfma_f32_32x32x16_bf16 v[24:39], v[48:51], v[100:103], 0
    v_exp_f32 v84, v84
    v_exp_f32 v85, v85
    v_cvt_pk_bf16_f32 v233, v82, v83
    v_exp_f32 v86, v86
    v_exp_f32 v87, v87
    v_cvt_pk_bf16_f32 v234, v84, v85
    v_mfma_f32_32x32x8_bf16 v[24:39], v[42:43], v[106:107], v[24:39]
    ds_read_b128 v[48:51], v125 offset:36064
    ds_read_b64 v[42:43], v127 offset:36064
    v_exp_f32 v88, v88
    v_exp_f32 v89, v89
    v_cvt_pk_bf16_f32 v235, v86, v87
    v_exp_f32 v90, v90
    v_exp_f32 v91, v91
    v_cvt_pk_bf16_f32 v236, v88, v89
    s_waitcnt lgkmcnt(8)
    v_mfma_f32_32x32x16_bf16 v[64:79], v[244:247], v[228:231], v[64:79]
    ds_read_b64_tr_b16 v[240:241], v120 offset:20608
    ds_read_b64_tr_b16 v[242:243], v121 offset:20608
    ds_read_b64_tr_b16 v[244:245], v122 offset:20608
    ds_read_b64_tr_b16 v[246:247], v123 offset:20608
    v_exp_f32 v92, v92
    v_exp_f32 v93, v93
    v_cvt_pk_bf16_f32 v237, v90, v91
    v_exp_f32 v94, v94
    v_exp_f32 v95, v95
    v_cvt_pk_bf16_f32 v238, v92, v93
    s_waitcnt lgkmcnt(8)
    v_mfma_f32_32x32x16_bf16 v[64:79], v[248:251], v[232:235], v[64:79]
    v_cvt_pk_bf16_f32 v239, v94, v95
    v_exp_f32 v24, v24
    v_exp_f32 v25, v25
    v_exp_f32 v26, v26
    v_exp_f32 v27, v27
    v_cvt_pk_bf16_f32 v224, v24, v25
    v_mfma_f32_32x32x16_bf16 v[80:95], v[56:59], v[100:103], 0
    v_exp_f32 v28, v28
    v_exp_f32 v29, v29
    v_cvt_pk_bf16_f32 v225, v26, v27
    v_exp_f32 v30, v30
    v_exp_f32 v31, v31
    v_cvt_pk_bf16_f32 v226, v28, v29
    v_mfma_f32_32x32x8_bf16 v[80:95], v[46:47], v[106:107], v[80:95]
    v_exp_f32 v32, v32
    v_exp_f32 v33, v33
    v_cvt_pk_bf16_f32 v227, v30, v31
    v_exp_f32 v34, v34
    v_exp_f32 v35, v35
    v_cvt_pk_bf16_f32 v228, v32, v33
    s_waitcnt lgkmcnt(6)
    v_mfma_f32_32x32x16_bf16 v[64:79], v[252:255], v[236:239], v[64:79]
    ds_read_b64_tr_b16 v[248:249], v120 offset:25760
    ds_read_b64_tr_b16 v[250:251], v121 offset:25760
    ds_read_b64_tr_b16 v[252:253], v122 offset:25760
    ds_read_b64_tr_b16 v[254:255], v123 offset:25760
    v_exp_f32 v36, v36
    v_exp_f32 v37, v37
    v_cvt_pk_bf16_f32 v229, v34, v35
    v_exp_f32 v38, v38
    v_exp_f32 v39, v39
    v_cvt_pk_bf16_f32 v230, v36, v37
    s_waitcnt lgkmcnt(6)
    v_mfma_f32_32x32x16_bf16 v[64:79], v[240:243], v[224:227], v[64:79]
    v_cvt_pk_bf16_f32 v231, v38, v39
    v_exp_f32 v80, v80
    v_exp_f32 v81, v81
    v_exp_f32 v82, v82
    v_exp_f32 v83, v83
    v_cvt_pk_bf16_f32 v232, v80, v81
    v_mfma_f32_32x32x16_bf16 v[24:39], v[52:55], v[100:103], 0
    v_exp_f32 v84, v84
    v_exp_f32 v85, v85
    v_cvt_pk_bf16_f32 v233, v82, v83
    v_exp_f32 v86, v86
    v_exp_f32 v87, v87
    v_cvt_pk_bf16_f32 v234, v84, v85
    v_mfma_f32_32x32x8_bf16 v[24:39], v[44:45], v[106:107], v[24:39]
    v_exp_f32 v88, v88
    v_exp_f32 v89, v89
    v_cvt_pk_bf16_f32 v235, v86, v87
    v_exp_f32 v90, v90
    v_exp_f32 v91, v91
    v_cvt_pk_bf16_f32 v236, v88, v89
    s_waitcnt lgkmcnt(4)
    v_mfma_f32_32x32x16_bf16 v[64:79], v[244:247], v[228:231], v[64:79]
    ds_read_b64_tr_b16 v[240:241], v120 offset:30912
    ds_read_b64_tr_b16 v[242:243], v121 offset:30912
    ds_read_b64_tr_b16 v[244:245], v122 offset:30912
    ds_read_b64_tr_b16 v[246:247], v123 offset:30912
    v_exp_f32 v92, v92
    v_exp_f32 v93, v93
    v_cvt_pk_bf16_f32 v237, v90, v91
    v_exp_f32 v94, v94
    v_exp_f32 v95, v95
    v_cvt_pk_bf16_f32 v238, v92, v93
    s_waitcnt lgkmcnt(6)
    v_mfma_f32_32x32x16_bf16 v[64:79], v[248:251], v[232:235], v[64:79]
    v_cvt_pk_bf16_f32 v239, v94, v95
    v_exp_f32 v24, v24
    v_exp_f32 v25, v25
    v_exp_f32 v26, v26
    v_exp_f32 v27, v27
    v_cvt_pk_bf16_f32 v224, v24, v25
    v_mfma_f32_32x32x16_bf16 v[80:95], v[48:51], v[100:103], 0
    v_exp_f32 v28, v28
    v_exp_f32 v29, v29
    v_cvt_pk_bf16_f32 v225, v26, v27
    v_exp_f32 v30, v30
    v_exp_f32 v31, v31
    v_cvt_pk_bf16_f32 v226, v28, v29
    v_mfma_f32_32x32x8_bf16 v[80:95], v[42:43], v[106:107], v[80:95]
    v_exp_f32 v32, v32
    v_exp_f32 v33, v33
    v_cvt_pk_bf16_f32 v227, v30, v31
    v_exp_f32 v34, v34
    v_exp_f32 v35, v35
    v_cvt_pk_bf16_f32 v228, v32, v33
    s_waitcnt lgkmcnt(4)
    v_mfma_f32_32x32x16_bf16 v[64:79], v[252:255], v[236:239], v[64:79]
    ds_read_b64_tr_b16 v[248:249], v120 offset:36064
    ds_read_b64_tr_b16 v[250:251], v121 offset:36064
    ds_read_b64_tr_b16 v[252:253], v122 offset:36064
    ds_read_b64_tr_b16 v[254:255], v123 offset:36064
    v_exp_f32 v36, v36
    v_exp_f32 v37, v37
    v_cvt_pk_bf16_f32 v229, v34, v35
    v_exp_f32 v38, v38
    v_exp_f32 v39, v39
    v_cvt_pk_bf16_f32 v230, v36, v37
    s_waitcnt lgkmcnt(6)
    v_mfma_f32_32x32x16_bf16 v[64:79], v[240:243], v[224:227], v[64:79]
    v_cvt_pk_bf16_f32 v231, v38, v39
    v_exp_f32 v80, v80
    v_mov_b32 v5, 101168
    ds_read_b128 v[108:111], v5
    v_exp_f32 v81, v81
    v_exp_f32 v82, v82
    v_exp_f32 v83, v83
    v_cvt_pk_bf16_f32 v232, v80, v81
    s_waitcnt lgkmcnt(5)
    v_mfma_f32_32x32x16_bf16 v[64:79], v[244:247], v[228:231], v[64:79]
    v_exp_f32 v84, v84
    v_exp_f32 v85, v85
    v_cvt_pk_bf16_f32 v233, v82, v83
    v_exp_f32 v86, v86
    v_exp_f32 v87, v87
    v_cvt_pk_bf16_f32 v234, v84, v85
    v_exp_f32 v88, v88
    v_exp_f32 v89, v89
    v_cvt_pk_bf16_f32 v235, v86, v87
    v_exp_f32 v90, v90
    v_exp_f32 v91, v91
    v_cvt_pk_bf16_f32 v236, v88, v89
    v_exp_f32 v92, v92
    v_exp_f32 v93, v93
    v_cvt_pk_bf16_f32 v237, v90, v91
    v_exp_f32 v94, v94
    v_exp_f32 v95, v95
    v_cvt_pk_bf16_f32 v238, v92, v93
    s_waitcnt lgkmcnt(3)
    v_mfma_f32_32x32x16_bf16 v[64:79], v[248:251], v[232:235], v[64:79]
    v_cvt_pk_bf16_f32 v239, v94, v95
    s_waitcnt lgkmcnt(1)
    s_nop 0
    v_mfma_f32_32x32x16_bf16 v[64:79], v[252:255], v[236:239], v[64:79]
    s_mov_b32 s47, 0x21800000
    s_mov_b32 s48, 0x5d800000
    s_nop 9
    v_cmp_nlt_f32 vcc, s47, v76
    v_cmp_ngt_f32 s[50:51], s48, v76
    s_or_b64 vcc, vcc, s[50:51]
    s_cbranch_vccnz L_slow1
L_back1:
    v_rcp_f32 v3, v76
    s_nop 0
    v_mul_f32 v64, v3, v64
    v_mul_f32 v65, v3, v65
    v_mul_f32 v66, v3, v66
    v_mul_f32 v67, v3, v67
    v_mul_f32 v68, v3, v68
    v_mul_f32 v69, v3, v69
    v_mul_f32 v70, v3, v70
    v_mul_f32 v71, v3, v71
    v_mul_f32 v72, v3, v72
    v_mul_f32 v73, v3, v73
    v_mul_f32 v74, v3, v74
    v_mul_f32 v75, v3, v75
    v_cvt_pk_bf16_f32 v64, v64, v65
    v_cvt_pk_bf16_f32 v65, v66, v67
    v_cvt_pk_bf16_f32 v66, v68, v69
    v_cvt_pk_bf16_f32 v67, v70, v71
    v_cvt_pk_bf16_f32 v62, v72, v73
    v_cvt_pk_bf16_f32 v63, v74, v75
    v_min_u32 v64, -2, v64
    v_min_u32 v65, -2, v65
    v_min_u32 v66, -2, v66
    v_min_u32 v67, -2, v67
    v_min_u32 v62, -2, v62
    v_min_u32 v63, -2, v63
    buffer_store_dwordx4 v[64:67], v0, s[20:23], s95 offen sc1
    s_cmp_lg_u32 s92, 0
    s_cbranch_scc1 L_slow0
L_back0:
    s_sub_u32 s47, s40, 256
    s_mov_b64 exec, 0xffffffff
    buffer_store_dwordx4 v[60:63], v0, s[20:23], s47 offen sc1
    s_mov_b64 exec, -1
    s_setprio 1
    v_and_b32 v8, 0x300, v0
    v_add3_u32 v8, v8, v0, s55
    s_waitcnt lgkmcnt(0)
    v_min3_u32 v108, v108, v109, v110
    v_min_u32 v108, v108, v111
    v_cmp_eq_u32 vcc, 0, v108
    s_cbranch_vccnz L_lr3
L_lb3:
    s_mov_b32 s98, 49152
    buffer_load_dwordx4 v[208:211], v8, s[20:23], s98 offen offset:0 sc1
    buffer_load_dwordx4 v[212:215], v8, s[20:23], s98 offen offset:256 sc1
    buffer_load_dwordx4 v[216:219], v8, s[20:23], s98 offen offset:2048 sc1
    buffer_load_dwordx4 v[220:223], v8, s[20:23], s98 offen offset:2304 sc1
    s_mov_b32 s98, 53248
    buffer_load_dwordx4 v[224:227], v8, s[20:23], s98 offen offset:0 sc1
    buffer_load_dwordx4 v[228:231], v8, s[20:23], s98 offen offset:256 sc1
    buffer_load_dwordx4 v[232:235], v8, s[20:23], s98 offen offset:2048 sc1
    buffer_load_dwordx4 v[236:239], v8, s[20:23], s98 offen offset:2304 sc1
    s_waitcnt vmcnt(7)
    v_max3_u32 v6, v208, v209, v210
    s_waitcnt vmcnt(6)
    v_max3_u32 v7, v211, v212, v213
    v_max3_u32 v6, v6, v214, v215
    s_waitcnt vmcnt(5)
    v_max3_u32 v7, v7, v216, v217
    v_max3_u32 v6, v6, v218, v219
    s_waitcnt vmcnt(4)
    v_max3_u32 v7, v7, v220, v221
    v_max3_u32 v6, v6, v222, v223
    v_max_u32 v6, v6, v7
    v_cmp_eq_u32 vcc, -1, v6
    s_cbranch_vccnz L_hra0
L_hba0:
    v_mfma_f32_16x16x32_bf16 v[16:19], v[128:131], v[208:211], 0
    v_mfma_f32_16x16x32_bf16 v[20:23], v[128:131], v[212:215], 0
    v_mfma_f32_16x16x32_bf16 v[24:27], v[128:131], v[216:219], 0
    v_mfma_f32_16x16x32_bf16 v[28:31], v[128:131], v[220:223], 0
    s_add_u32 s99, s31, 81920
    buffer_load_dwordx4 v[240:243], v0, s[20:23], s99 offen offset:0 sc1
    v_mfma_f32_16x16x32_bf16 v[32:35], v[132:135], v[208:211], 0
    v_mfma_f32_16x16x32_bf16 v[36:39], v[132:135], v[212:215], 0
    v_mfma_f32_16x16x32_bf16 v[40:43], v[132:135], v[216:219], 0
    v_mfma_f32_16x16x32_bf16 v[44:47], v[132:135], v[220:223], 0
    buffer_load_dwordx4 v[244:247], v0, s[20:23], s99 offen offset:1024 sc1
    v_mfma_f32_16x16x32_bf16 v[48:51], v[136:139], v[208:211], 0
    v_mfma_f32_16x16x32_bf16 v[52:55], v[136:139], v[212:215], 0
    v_mfma_f32_16x16x32_bf16 v[56:59], v[136:139], v[216:219], 0
    v_mfma_f32_16x16x32_bf16 v[60:63], v[136:139], v[220:223], 0
    buffer_load_dwordx4 v[248:251], v0, s[20:23], s99 offen offset:2048 sc1
    v_mfma_f32_16x16x32_bf16 v[64:67], v[140:143], v[208:211], 0
    v_mfma_f32_16x16x32_bf16 v[68:71], v[140:143], v[212:215], 0
    v_mfma_f32_16x16x32_bf16 v[72:75], v[140:143], v[216:219], 0
    v_mfma_f32_16x16x32_bf16 v[76:79], v[140:143], v[220:223], 0
    buffer_load_dwordx4 v[252:255], v0, s[20:23], s99 offen offset:3072 sc1
    v_mfma_f32_16x16x32_bf16 v[80:83], v[144:147], v[208:211], 0
    s_add_u32 s99, s31, 86016
    buffer_load_dwordx4 v[96:99], v0, s[20:23], s99 offen offset:0 sc1
    v_mfma_f32_16x16x32_bf16 v[84:87], v[144:147], v[212:215], 0
    v_mfma_f32_16x16x32_bf16 v[88:91], v[144:147], v[216:219], 0
    v_mfma_f32_16x16x32_bf16 v[92:95], v[144:147], v[220:223], 0
    s_waitcnt vmcnt(8)
    v_max3_u32 v6, v224, v225, v226
    s_waitcnt vmcnt(7)
    v_max3_u32 v7, v227, v228, v229
    v_max3_u32 v6, v6, v230, v231
    s_waitcnt vmcnt(6)
    v_max3_u32 v7, v7, v232, v233
    v_max3_u32 v6, v6, v234, v235
    s_waitcnt vmcnt(5)
    v_max3_u32 v7, v7, v236, v237
    v_max3_u32 v6, v6, v238, v239
    v_max_u32 v6, v6, v7
    v_cmp_eq_u32 vcc, -1, v6
    s_cbranch_vccnz L_hra1
L_hba1:
    v_mfma_f32_16x16x32_bf16 v[16:19], v[148:151], v[224:227], v[16:19]
    s_mov_b32 s98, 57344
    buffer_load_dwordx4 v[100:103], v8, s[20:23], s98 offen offset:0 sc1
    s_mul_i32 s47, s36, 20480
    s_add_u32 s47, s47, 81920
    v_add_u32 v9, s47, v0
    v_mfma_f32_16x16x32_bf16 v[20:23], v[148:151], v[228:231], v[20:23]
    buffer_load_dwordx4 v[104:107], v8, s[20:23], s98 offen offset:256 sc1
    v_mfma_f32_16x16x32_bf16 v[24:27], v[148:151], v[232:235], v[24:27]
    buffer_load_dwordx4 v[108:111], v8, s[20:23], s98 offen offset:2048 sc1
    v_mfma_f32_16x16x32_bf16 v[28:31], v[148:151], v[236:239], v[28:31]
    buffer_load_dwordx4 v[112:115], v8, s[20:23], s98 offen offset:2304 sc1
    v_mfma_f32_16x16x32_bf16 v[32:35], v[152:155], v[224:227], v[32:35]
    s_mov_b32 s98, 61440
    buffer_load_dwordx4 v[116:119], v8, s[20:23], s98 offen offset:0 sc1
    v_mfma_f32_16x16x32_bf16 v[36:39], v[152:155], v[228:231], v[36:39]
    buffer_load_dwordx4 v[120:123], v8, s[20:23], s98 offen offset:256 sc1
    v_mfma_f32_16x16x32_bf16 v[40:43], v[152:155], v[232:235], v[40:43]
    buffer_load_dwordx4 v[124:127], v8, s[20:23], s98 offen offset:2048 sc1
    v_mfma_f32_16x16x32_bf16 v[44:47], v[152:155], v[236:239], v[44:47]
    buffer_load_dwordx4 v[128:131], v8, s[20:23], s98 offen offset:2304 sc1
    v_mfma_f32_16x16x32_bf16 v[48:51], v[156:159], v[224:227], v[48:51]
    v_mfma_f32_16x16x32_bf16 v[52:55], v[156:159], v[228:231], v[52:55]
    v_mfma_f32_16x16x32_bf16 v[56:59], v[156:159], v[232:235], v[56:59]
    v_mfma_f32_16x16x32_bf16 v[60:63], v[156:159], v[236:239], v[60:63]
    v_mfma_f32_16x16x32_bf16 v[64:67], v[160:163], v[224:227], v[64:67]
    v_mfma_f32_16x16x32_bf16 v[68:71], v[160:163], v[228:231], v[68:71]
    v_mfma_f32_16x16x32_bf16 v[72:75], v[160:163], v[232:235], v[72:75]
    v_mfma_f32_16x16x32_bf16 v[76:79], v[160:163], v[236:239], v[76:79]
    v_mfma_f32_16x16x32_bf16 v[80:83], v[164:167], v[224:227], v[80:83]
    v_mfma_f32_16x16x32_bf16 v[84:87], v[164:167], v[228:231], v[84:87]
    v_mfma_f32_16x16x32_bf16 v[88:91], v[164:167], v[232:235], v[88:91]
    v_mfma_f32_16x16x32_bf16 v[92:95], v[164:167], v[236:239], v[92:95]
    s_barrier
    s_waitcnt vmcnt(7)
    v_max3_u32 v6, v100, v101, v102
    s_waitcnt vmcnt(6)
    v_max3_u32 v7, v103, v104, v105
    v_max3_u32 v6, v6, v106, v107
    s_waitcnt vmcnt(5)
    v_max3_u32 v7, v7, v108, v109
    v_max3_u32 v6, v6, v110, v111
    s_waitcnt vmcnt(4)
    v_max3_u32 v7, v7, v112, v113
    v_max3_u32 v6, v6, v114, v115
    v_max_u32 v6, v6, v7
    v_cmp_eq_u32 vcc, -1, v6
    s_cbranch_vccnz L_hra2
L_hba2:
    v_mfma_f32_16x16x32_bf16 v[16:19], v[168:171], v[100:103], v[16:19]
    s_mov_b32 s98, 65536
    buffer_load_dwordx4 v[132:135], v8, s[20:23], s98 offen offset:0 sc1
    v_mfma_f32_16x16x32_bf16 v[20:23], v[168:171], v[104:107], v[20:23]
    buffer_load_dwordx4 v[136:139], v8, s[20:23], s98 offen offset:256 sc1
    v_mfma_f32_16x16x32_bf16 v[24:27], v[168:171], v[108:111], v[24:27]
    buffer_load_dwordx4 v[140:143], v8, s[20:23], s98 offen offset:2048 sc1
    v_mfma_f32_16x16x32_bf16 v[28:31], v[168:171], v[112:115], v[28:31]
    buffer_load_dwordx4 v[208:211], v8, s[20:23], s98 offen offset:2304 sc1
    v_mfma_f32_16x16x32_bf16 v[32:35], v[172:175], v[100:103], v[32:35]
    v_mfma_f32_16x16x32_bf16 v[36:39], v[172:175], v[104:107], v[36:39]
    v_mfma_f32_16x16x32_bf16 v[40:43], v[172:175], v[108:111], v[40:43]
    v_mfma_f32_16x16x32_bf16 v[44:47], v[172:175], v[112:115], v[44:47]
    v_mfma_f32_16x16x32_bf16 v[48:51], v[176:179], v[100:103], v[48:51]
    v_mfma_f32_16x16x32_bf16 v[52:55], v[176:179], v[104:107], v[52:55]
    v_mfma_f32_16x16x32_bf16 v[56:59], v[176:179], v[108:111], v[56:59]
    v_mfma_f32_16x16x32_bf16 v[60:63], v[176:179], v[112:115], v[60:63]
    v_mfma_f32_16x16x32_bf16 v[64:67], v[180:183], v[100:103], v[64:67]
    v_mfma_f32_16x16x32_bf16 v[68:71], v[180:183], v[104:107], v[68:71]
    v_mfma_f32_16x16x32_bf16 v[72:75], v[180:183], v[108:111], v[72:75]
    v_mfma_f32_16x16x32_bf16 v[76:79], v[180:183], v[112:115], v[76:79]
    v_mfma_f32_16x16x32_bf16 v[80:83], v[184:187], v[100:103], v[80:83]
    v_mfma_f32_16x16x32_bf16 v[84:87], v[184:187], v[104:107], v[84:87]
    v_mfma_f32_16x16x32_bf16 v[88:91], v[184:187], v[108:111], v[88:91]
    v_mfma_f32_16x16x32_bf16 v[92:95], v[184:187], v[112:115], v[92:95]
    s_waitcnt vmcnt(7)
    v_max3_u32 v6, v116, v117, v118
    s_waitcnt vmcnt(6)
    v_max3_u32 v7, v119, v120, v121
    v_max3_u32 v6, v6, v122, v123
    s_waitcnt vmcnt(5)
    v_max3_u32 v7, v7, v124, v125
    v_max3_u32 v6, v6, v126, v127
    s_waitcnt vmcnt(4)
    v_max3_u32 v7, v7, v128, v129
    v_max3_u32 v6, v6, v130, v131
    v_max_u32 v6, v6, v7
    v_cmp_eq_u32 vcc, -1, v6
    s_cbranch_vccnz L_hra3
L_hba3:
    v_mfma_f32_16x16x32_bf16 v[16:19], v[188:191], v[116:119], v[16:19]
    v_mfma_f32_16x16x32_bf16 v[20:23], v[188:191], v[120:123], v[20:23]
    v_mfma_f32_16x16x32_bf16 v[24:27], v[188:191], v[124:127], v[24:27]
    v_mfma_f32_16x16x32_bf16 v[28:31], v[188:191], v[128:131], v[28:31]
    v_mfma_f32_16x16x32_bf16 v[32:35], v[192:195], v[116:119], v[32:35]
    v_mfma_f32_16x16x32_bf16 v[36:39], v[192:195], v[120:123], v[36:39]
    v_mfma_f32_16x16x32_bf16 v[40:43], v[192:195], v[124:127], v[40:43]
    v_mfma_f32_16x16x32_bf16 v[44:47], v[192:195], v[128:131], v[44:47]
    v_mfma_f32_16x16x32_bf16 v[48:51], v[196:199], v[116:119], v[48:51]
    v_mfma_f32_16x16x32_bf16 v[52:55], v[196:199], v[120:123], v[52:55]
    v_mfma_f32_16x16x32_bf16 v[56:59], v[196:199], v[124:127], v[56:59]
    v_mfma_f32_16x16x32_bf16 v[60:63], v[196:199], v[128:131], v[60:63]
    v_mfma_f32_16x16x32_bf16 v[64:67], v[200:203], v[116:119], v[64:67]
    v_mfma_f32_16x16x32_bf16 v[68:71], v[200:203], v[120:123], v[68:71]
    v_mfma_f32_16x16x32_bf16 v[72:75], v[200:203], v[124:127], v[72:75]
    v_mfma_f32_16x16x32_bf16 v[76:79], v[200:203], v[128:131], v[76:79]
    v_mfma_f32_16x16x32_bf16 v[80:83], v[204:207], v[116:119], v[80:83]
    v_mfma_f32_16x16x32_bf16 v[84:87], v[204:207], v[120:123], v[84:87]
    v_mfma_f32_16x16x32_bf16 v[88:91], v[204:207], v[124:127], v[88:91]
    v_mfma_f32_16x16x32_bf16 v[92:95], v[204:207], v[128:131], v[92:95]
    s_waitcnt vmcnt(3)
    v_max3_u32 v6, v132, v133, v134
    s_waitcnt vmcnt(2)
    v_max3_u32 v7, v135, v136, v137
    v_max3_u32 v6, v6, v138, v139
    s_waitcnt vmcnt(1)
    v_max3_u32 v7, v7, v140, v141
    v_max3_u32 v6, v6, v142, v143
    s_waitcnt vmcnt(0)
    v_max3_u32 v7, v7, v208, v209
    v_max3_u32 v6, v6, v210, v211
    v_max_u32 v6, v6, v7
    v_cmp_eq_u32 vcc, -1, v6
    s_cbranch_vccnz L_hra4
L_hba4:
    v_mfma_f32_16x16x32_bf16 v[16:19], v[240:243], v[132:135], v[16:19]
    v_mfma_f32_16x16x32_bf16 v[20:23], v[240:243], v[136:139], v[20:23]
    v_mfma_f32_16x16x32_bf16 v[24:27], v[240:243], v[140:143], v[24:27]
    v_mfma_f32_16x16x32_bf16 v[28:31], v[240:243], v[208:211], v[28:31]
    v_mfma_f32_16x16x32_bf16 v[32:35], v[244:247], v[132:135], v[32:35]
    s_nop 3
    ds_write_b128 v9, v[16:19] offset:0
    v_mfma_f32_16x16x32_bf16 v[36:39], v[244:247], v[136:139], v[36:39]
    ds_write_b128 v9, v[20:23] offset:1024
    v_mfma_f32_16x16x32_bf16 v[40:43], v[244:247], v[140:143], v[40:43]
    ds_write_b128 v9, v[24:27] offset:2048
    v_mfma_f32_16x16x32_bf16 v[44:47], v[244:247], v[208:211], v[44:47]
    ds_write_b128 v9, v[28:31] offset:3072
    v_mfma_f32_16x16x32_bf16 v[48:51], v[248:251], v[132:135], v[48:51]
    ds_write_b128 v9, v[32:35] offset:4096
    v_mfma_f32_16x16x32_bf16 v[52:55], v[248:251], v[136:139], v[52:55]
    ds_write_b128 v9, v[36:39] offset:5120
    v_mfma_f32_16x16x32_bf16 v[56:59], v[248:251], v[140:143], v[56:59]
    ds_write_b128 v9, v[40:43] offset:6144
    v_mfma_f32_16x16x32_bf16 v[60:63], v[248:251], v[208:211], v[60:63]
    ds_write_b128 v9, v[44:47] offset:7168
    v_mfma_f32_16x16x32_bf16 v[64:67], v[252:255], v[132:135], v[64:67]
    ds_write_b128 v9, v[48:51] offset:8192
    v_mfma_f32_16x16x32_bf16 v[68:71], v[252:255], v[136:139], v[68:71]
    ds_write_b128 v9, v[52:55] offset:9216
    s_waitcnt lgkmcnt(2)
    s_barrier
    v_mfma_f32_16x16x32_bf16 v[72:75], v[252:255], v[140:143], v[72:75]
    ds_write_b128 v9, v[56:59] offset:10240
    v_mfma_f32_16x16x32_bf16 v[76:79], v[252:255], v[208:211], v[76:79]
    ds_write_b128 v9, v[60:63] offset:11264
    v_mfma_f32_16x16x32_bf16 v[80:83], v[96:99], v[132:135], v[80:83]
    ds_write_b128 v9, v[64:67] offset:12288
    v_mfma_f32_16x16x32_bf16 v[84:87], v[96:99], v[136:139], v[84:87]
    ds_write_b128 v9, v[68:71] offset:13312
    s_waitcnt lgkmcnt(2)
    s_barrier
    v_mfma_f32_16x16x32_bf16 v[88:91], v[96:99], v[140:143], v[88:91]
    ds_write_b128 v9, v[72:75] offset:14336
    v_mfma_f32_16x16x32_bf16 v[92:95], v[96:99], v[208:211], v[92:95]
    ds_write_b128 v9, v[76:79] offset:15360
    ds_write_b128 v9, v[80:83] offset:16384
    ds_write_b128 v9, v[84:87] offset:17408
    s_nop 2
    ds_write_b128 v9, v[88:91] offset:18432
    s_nop 0
    ds_write_b128 v9, v[92:95] offset:19456
    s_waitcnt lgkmcnt(0)
    s_barrier
    s_endpgm
Ltl_2_e:
    s_mov_b32 s1, 0
Ltl_2:
    buffer_load_dword v87, off, s[32:35], 0 offset:128 sc1
    s_add_u32 s1, s1, 1
    s_waitcnt vmcnt(0)
    v_readfirstlane_b32 s45, v87
    s_cmp_gt_u32 s1, 200000
    s_cbranch_scc1 Ltd_1
    s_cmp_eq_u32 s45, 0
    s_cbranch_scc1 Ltl_2
    s_branch Ltd_1
Lpl_4_e:
    s_mov_b32 s1, 0
Lpl_4:
    s_sleep 1
    buffer_load_dwordx2 v[88:89], v90, s[20:23], 0 offen sc1
    s_add_u32 s1, s1, 1
    s_waitcnt vmcnt(0)
    v_cmp_ne_u32 vcc, s45, v89
    s_cmp_gt_u32 s1, 200000
    s_cbranch_scc1 Lpd_3
    s_cbranch_vccnz Lpl_4
    s_branch Lpd_3
Lfl_6_e:
    s_mov_b32 m0, 0
Lfl_6:
    s_sleep 4
    s_mov_b64 exec, s[0:1]
    buffer_load_dword v72, v73, s[20:23], s35 offen offset:8 sc1
    s_mov_b64 exec, -1
    s_add_u32 m0, m0, 1
    s_cmp_gt_u32 m0, 200000
    s_cbranch_scc1 Lfd_5
    s_waitcnt vmcnt(0)
    v_cmp_ne_u32 s[0:1], s45, v72
    s_cmp_lg_u64 s[0:1], 0
    s_cbranch_scc1 Lfl_6
    s_branch Lfd_5
Lfl_8_e:
    s_mov_b32 m0, 0
Lfl_8:
    s_sleep 4
    s_mov_b64 exec, s[0:1]
    buffer_load_dword v74, v75, s[20:23], s35 offen offset:8 sc1
    s_mov_b64 exec, -1
    s_add_u32 m0, m0, 1
    s_cmp_gt_u32 m0, 200000
    s_cbranch_scc1 Lfd_7
    s_waitcnt vmcnt(0)
    v_cmp_ne_u32 s[0:1], s45, v74
    s_cmp_lg_u64 s[0:1], 0
    s_cbranch_scc1 Lfl_8
    s_branch Lfd_7
L_lr2:
    s_mov_b32 s1, 0
L_ll2:
    ds_read_b128 v[56:59], v5
    s_add_u32 s1, s1, 1
    s_waitcnt lgkmcnt(0)
    v_min3_u32 v56, v56, v57, v58
    v_min_u32 v56, v56, v59
    v_cmp_eq_u32 vcc, 0, v56
    s_cmp_gt_u32 s1, 1000000
    s_cbranch_scc1 L_lb2
    s_cbranch_vccnz L_ll2
    s_branch L_lb2
L_lr0:
    s_mov_b32 s1, 0
L_ll0:
    ds_read_b128 v[56:59], v5
    ds_read_b128 v[12:15], v17 offset:0
    s_add_u32 s1, s1, 1
    s_waitcnt lgkmcnt(0)
    v_min3_u32 v56, v56, v57, v58
    v_min_u32 v56, v56, v59
    v_cmp_eq_u32 vcc, 0, v56
    s_cmp_gt_u32 s1, 1000000
    s_cbranch_scc1 L_lb0
    s_cbranch_vccnz L_ll0
    s_branch L_lb0
Lfl_10_e:
    s_mov_b32 m0, 0
Lfl_10:
    s_sleep 4
    s_mov_b64 exec, s[0:1]
    buffer_load_dword v10, v11, s[20:23], s30 offen offset:8 sc1
    s_mov_b64 exec, -1
    s_add_u32 m0, m0, 1
    s_cmp_gt_u32 m0, 200000
    s_cbranch_scc1 Lfd_9
    s_waitcnt vmcnt(0)
    v_cmp_ne_u32 s[0:1], s45, v10
    s_cmp_lg_u64 s[0:1], 0
    s_cbranch_scc1 Lfl_10
    s_branch Lfd_9
L_hrg8:
    s_mov_b32 s1, 0
L_hlg8:
    s_mov_b32 s0, 32768
    s_mov_b64 exec, vcc
    buffer_load_dwordx4 v[220:223], v8, s[20:23], s0 offen offset:0 sc1
    buffer_load_dwordx4 v[228:231], v8, s[20:23], s0 offen offset:256 sc1
    buffer_load_dwordx4 v[164:167], v8, s[20:23], s0 offen offset:2048 sc1
    buffer_load_dwordx4 v[108:111], v8, s[20:23], s0 offen offset:2304 sc1
    s_mov_b64 exec, -1
    s_add_u32 s1, s1, 1
    s_waitcnt vmcnt(0)
    v_max3_u32 v6, v220, v221, v222
    v_max3_u32 v7, v223, v228, v229
    v_max3_u32 v6, v6, v230, v231
    v_max3_u32 v7, v7, v164, v165
    v_max3_u32 v6, v6, v166, v167
    v_max3_u32 v7, v7, v108, v109
    v_max3_u32 v6, v6, v110, v111
    v_max_u32 v6, v6, v7
    v_cmp_eq_u32 vcc, -1, v6
    s_cmp_gt_u32 s1, 200000
    s_cbranch_scc1 L_hbg8
    s_cbranch_vccz L_hbg8
    s_sleep 4
    s_branch L_hlg8
L_hrg9:
    s_mov_b32 s1, 0
L_hlg9:
    s_mov_b32 s0, 36864
    s_mov_b64 exec, vcc
    buffer_load_dwordx4 v[116:119], v8, s[20:23], s0 offen offset:0 sc1
    buffer_load_dwordx4 v[120:123], v8, s[20:23], s0 offen offset:256 sc1
    buffer_load_dwordx4 v[172:175], v8, s[20:23], s0 offen offset:2048 sc1
    buffer_load_dwordx4 v[124:127], v8, s[20:23], s0 offen offset:2304 sc1
    s_mov_b64 exec, -1
    s_add_u32 s1, s1, 1
    s_waitcnt vmcnt(0)
    v_max3_u32 v6, v116, v117, v118
    v_max3_u32 v7, v119, v120, v121
    v_max3_u32 v6, v6, v122, v123
    v_max3_u32 v7, v7, v172, v173
    v_max3_u32 v6, v6, v174, v175
    v_max3_u32 v7, v7, v124, v125
    v_max3_u32 v6, v6, v126, v127
    v_max_u32 v6, v6, v7
    v_cmp_eq_u32 vcc, -1, v6
    s_cmp_gt_u32 s1, 200000
    s_cbranch_scc1 L_hbg9
    s_cbranch_vccz L_hbg9
    s_sleep 4
    s_branch L_hlg9
L_hrg10:
    s_mov_b32 s1, 0
L_hlg10:
    s_mov_b32 s0, 40960
    s_mov_b64 exec, vcc
    buffer_load_dwordx4 v[236:239], v8, s[20:23], s0 offen offset:0 sc1
    buffer_load_dwordx4 v[244:247], v8, s[20:23], s0 offen offset:256 sc1
    buffer_load_dwordx4 v[200:203], v8, s[20:23], s0 offen offset:2048 sc1
    buffer_load_dwordx4 v[248:251], v8, s[20:23], s0 offen offset:2304 sc1
    s_mov_b64 exec, -1
    s_add_u32 s1, s1, 1
    s_waitcnt vmcnt(0)
    v_max3_u32 v6, v236, v237, v238
    v_max3_u32 v7, v239, v244, v245
    v_max3_u32 v6, v6, v246, v247
    v_max3_u32 v7, v7, v200, v201
    v_max3_u32 v6, v6, v202, v203
    v_max3_u32 v7, v7, v248, v249
    v_max3_u32 v6, v6, v250, v251
    v_max_u32 v6, v6, v7
    v_cmp_eq_u32 vcc, -1, v6
    s_cmp_gt_u32 s1, 200000
    s_cbranch_scc1 L_hbg10
    s_cbranch_vccz L_hbg10
    s_sleep 4
    s_branch L_hlg10
L_lr1:
    s_mov_b32 s1, 0
L_ll1:
    ds_read_b128 v[120:123], v5
    s_add_u32 s1, s1, 1
    s_waitcnt lgkmcnt(0)
    v_min3_u32 v120, v120, v121, v122
    v_min_u32 v120, v120, v123
    v_cmp_eq_u32 vcc, 0, v120
    s_cmp_gt_u32 s1, 1000000
    s_cbranch_scc1 L_lb1
    s_cbranch_vccnz L_ll1
    s_branch L_lb1
L_hrg11:
    s_mov_b32 s1, 0
L_hlg11:
    s_mov_b32 s0, 45056
    s_mov_b64 exec, vcc
    buffer_load_dwordx4 v[252:255], v8, s[20:23], s0 offen offset:0 sc1
    buffer_load_dwordx4 v[132:135], v8, s[20:23], s0 offen offset:256 sc1
    buffer_load_dwordx4 v[96:99], v8, s[20:23], s0 offen offset:2048 sc1
    buffer_load_dwordx4 v[136:139], v8, s[20:23], s0 offen offset:2304 sc1
    s_mov_b64 exec, -1
    s_add_u32 s1, s1, 1
    s_waitcnt vmcnt(0)
    v_max3_u32 v6, v252, v253, v254
    v_max3_u32 v7, v255, v132, v133
    v_max3_u32 v6, v6, v134, v135
    v_max3_u32 v7, v7, v96, v97
    v_max3_u32 v6, v6, v98, v99
    v_max3_u32 v7, v7, v136, v137
    v_max3_u32 v6, v6, v138, v139
    v_max_u32 v6, v6, v7
    v_cmp_eq_u32 vcc, -1, v6
    s_cmp_gt_u32 s1, 200000
    s_cbranch_scc1 L_hbg11
    s_cbranch_vccz L_hbg11
    s_sleep 4
    s_branch L_hlg11
Lfl_100002_e:
    s_mov_b32 m0, 0
Lfl_100002:
    s_sleep 4
    s_mov_b64 exec, s[0:1]
    buffer_load_dword v74, v75, s[20:23], s35 offen offset:8 sc1
    s_mov_b64 exec, -1
    s_add_u32 m0, m0, 1
    s_cmp_gt_u32 m0, 200000
    s_cbranch_scc1 Lfd_100001
    s_waitcnt vmcnt(0)
    v_cmp_ne_u32 s[0:1], s45, v74
    s_cmp_lg_u64 s[0:1], 0
    s_cbranch_scc1 Lfl_100002
    s_branch Lfd_100001
L_lr3:
    s_mov_b32 s1, 0
L_ll3:
    ds_read_b128 v[108:111], v5
    s_add_u32 s1, s1, 1
    s_waitcnt lgkmcnt(0)
    v_min3_u32 v108, v108, v109, v110
    v_min_u32 v108, v108, v111
    v_cmp_eq_u32 vcc, 0, v108
    s_cmp_gt_u32 s1, 1000000
    s_cbranch_scc1 L_lb3
    s_cbranch_vccnz L_ll3
    s_branch L_lb3
L_hra0:
    s_mov_b32 s1, 0
L_hla0:
    s_mov_b32 s0, 49152
    s_mov_b64 exec, vcc
    buffer_load_dwordx4 v[208:211], v8, s[20:23], s0 offen offset:0 sc1
    buffer_load_dwordx4 v[212:215], v8, s[20:23], s0 offen offset:256 sc1
    buffer_load_dwordx4 v[216:219], v8, s[20:23], s0 offen offset:2048 sc1
    buffer_load_dwordx4 v[220:223], v8, s[20:23], s0 offen offset:2304 sc1
    s_mov_b64 exec, -1
    s_add_u32 s1, s1, 1
    s_waitcnt vmcnt(0)
    v_max3_u32 v6, v208, v209, v210
    v_max3_u32 v7, v211, v212, v213
    v_max3_u32 v6, v6, v214, v215
    v_max3_u32 v7, v7, v216, v217
    v_max3_u32 v6, v6, v218, v219
    v_max3_u32 v7, v7, v220, v221
    v_max3_u32 v6, v6, v222, v223
    v_max_u32 v6, v6, v7
    v_cmp_eq_u32 vcc, -1, v6
    s_cmp_gt_u32 s1, 200000
    s_cbranch_scc1 L_hba0
    s_cbranch_vccz L_hba0
    s_sleep 4
    s_branch L_hla0
L_hra1:
    s_mov_b32 s1, 0
L_hla1:
    s_mov_b32 s0, 53248
    s_mov_b64 exec, vcc
    buffer_load_dwordx4 v[224:227], v8, s[20:23], s0 offen offset:0 sc1
    buffer_load_dwordx4 v[228:231], v8, s[20:23], s0 offen offset:256 sc1
    buffer_load_dwordx4 v[232:235], v8, s[20:23], s0 offen offset:2048 sc1
    buffer_load_dwordx4 v[236:239], v8, s[20:23], s0 offen offset:2304 sc1
    s_mov_b64 exec, -1
    s_add_u32 s1, s1, 1
    s_waitcnt vmcnt(0)
    v_max3_u32 v6, v224, v225, v226
    v_max3_u32 v7, v227, v228, v229
    v_max3_u32 v6, v6, v230, v231
    v_max3_u32 v7, v7, v232, v233
    v_max3_u32 v6, v6, v234, v235
    v_max3_u32 v7, v7, v236, v237
    v_max3_u32 v6, v6, v238, v239
    v_max_u32 v6, v6, v7
    v_cmp_eq_u32 vcc, -1, v6
    s_cmp_gt_u32 s1, 200000
    s_cbranch_scc1 L_hba1
    s_cbranch_vccz L_hba1
    s_sleep 4
    s_branch L_hla1
L_hra2:
    s_mov_b32 s1, 0
L_hla2:
    s_mov_b32 s0, 57344
    s_mov_b64 exec, vcc
    buffer_load_dwordx4 v[100:103], v8, s[20:23], s0 offen offset:0 sc1
    buffer_load_dwordx4 v[104:107], v8, s[20:23], s0 offen offset:256 sc1
    buffer_load_dwordx4 v[108:111], v8, s[20:23], s0 offen offset:2048 sc1
    buffer_load_dwordx4 v[112:115], v8, s[20:23], s0 offen offset:2304 sc1
    s_mov_b64 exec, -1
    s_add_u32 s1, s1, 1
    s_waitcnt vmcnt(0)
    v_max3_u32 v6, v100, v101, v102
    v_max3_u32 v7, v103, v104, v105
    v_max3_u32 v6, v6, v106, v107
    v_max3_u32 v7, v7, v108, v109
    v_max3_u32 v6, v6, v110, v111
    v_max3_u32 v7, v7, v112, v113
    v_max3_u32 v6, v6, v114, v115
    v_max_u32 v6, v6, v7
    v_cmp_eq_u32 vcc, -1, v6
    s_cmp_gt_u32 s1, 200000
    s_cbranch_scc1 L_hba2
    s_cbranch_vccz L_hba2
    s_sleep 4
    s_branch L_hla2
L_hra3:
    s_mov_b32 s1, 0
L_hla3:
    s_mov_b32 s0, 61440
    s_mov_b64 exec, vcc
    buffer_load_dwordx4 v[116:119], v8, s[20:23], s0 offen offset:0 sc1
    buffer_load_dwordx4 v[120:123], v8, s[20:23], s0 offen offset:256 sc1
    buffer_load_dwordx4 v[124:127], v8, s[20:23], s0 offen offset:2048 sc1
    buffer_load_dwordx4 v[128:131], v8, s[20:23], s0 offen offset:2304 sc1
    s_mov_b64 exec, -1
    s_add_u32 s1, s1, 1
    s_waitcnt vmcnt(0)
    v_max3_u32 v6, v116, v117, v118
    v_max3_u32 v7, v119, v120, v121
    v_max3_u32 v6, v6, v122, v123
    v_max3_u32 v7, v7, v124, v125
    v_max3_u32 v6, v6, v126, v127
    v_max3_u32 v7, v7, v128, v129
    v_max3_u32 v6, v6, v130, v131
    v_max_u32 v6, v6, v7
    v_cmp_eq_u32 vcc, -1, v6
    s_cmp_gt_u32 s1, 200000
    s_cbranch_scc1 L_hba3
    s_cbranch_vccz L_hba3
    s_sleep 4
    s_branch L_hla3
L_hra4:
    s_mov_b32 s1, 0
L_hla4:
    s_mov_b32 s0, 65536
    s_mov_b64 exec, vcc
    buffer_load_dwordx4 v[132:135], v8, s[20:23], s0 offen offset:0 sc1
    buffer_load_dwordx4 v[136:139], v8, s[20:23], s0 offen offset:256 sc1
    buffer_load_dwordx4 v[140:143], v8, s[20:23], s0 offen offset:2048 sc1
    buffer_load_dwordx4 v[208:211], v8, s[20:23], s0 offen offset:2304 sc1
    s_mov_b64 exec, -1
    s_add_u32 s1, s1, 1
    s_waitcnt vmcnt(0)
    v_max3_u32 v6, v132, v133, v134
    v_max3_u32 v7, v135, v136, v137
    v_max3_u32 v6, v6, v138, v139
    v_max3_u32 v7, v7, v140, v141
    v_max3_u32 v6, v6, v142, v143
    v_max3_u32 v7, v7, v208, v209
    v_max3_u32 v6, v6, v210, v211
    v_max_u32 v6, v6, v7
    v_cmp_eq_u32 vcc, -1, v6
    s_cmp_gt_u32 s1, 200000
    s_cbranch_scc1 L_hba4
    s_cbranch_vccz L_hba4
    s_sleep 4
    s_branch L_hla4
L_slow0:
    s_nop 15
    v_mov_b32 v6, 0x3f80
    v_cndmask_b32 v104, v104, v6, s[90:91]
    v_mov_b32 v6, 0xff800000
    v_mov_b32 v1, v6
    s_sub_i32 s49, 8, s46
    s_max_i32 s49, s49, 0
    s_mov_b32 s47, 0
    v_mov_b32 v208, 0
    v_mov_b32 v209, 0
    v_mov_b32 v210, 0
    v_mov_b32 v211, 0
    v_mov_b32 v212, 0
    v_mov_b32 v213, 0
    v_mov_b32 v214, 0
    v_mov_b32 v215, 0
    v_mov_b32 v216, 0
    v_mov_b32 v217, 0
    v_mov_b32 v218, 0
    v_mov_b32 v219, 0
    v_mov_b32 v220, 0
    v_mov_b32 v221, 0
    v_mov_b32 v222, 0
    v_mov_b32 v223, 0
L_s0_pass:
    s_mov_b32 s48, s49
L_s0_tile:
    s_mul_i32 s50, s48, 5152
    s_nop 15
    v_add_u32 v24, s50, v124
    v_add_u32 v25, s50, v126
    v_add_u32 v26, s50, v116
    v_add_u32 v27, s50, v117
    v_add_u32 v28, s50, v118
    v_add_u32 v29, s50, v119
    ds_read_b128 v[48:51], v24
    ds_read_b64 v[42:43], v25
    ds_read_b64_tr_b16 v[240:241], v26
    ds_read_b64_tr_b16 v[242:243], v27
    ds_read_b64_tr_b16 v[244:245], v28
    ds_read_b64_tr_b16 v[246:247], v29
    s_waitcnt lgkmcnt(0)
    v_mfma_f32_32x32x16_bf16 v[8:23], v[48:51], v[96:99], 0
    v_mfma_f32_32x32x8_bf16 v[8:23], v[42:43], v[104:105], v[8:23]
    s_nop 15
    s_cmp_lg_u32 s48, 0
    s_cbranch_scc1 L_s0_n0
    v_cndmask_b32 v8, v6, v8, s[56:57]
    v_cndmask_b32 v9, v6, v9, s[58:59]
    v_cndmask_b32 v10, v6, v10, s[60:61]
    v_cndmask_b32 v11, v6, v11, s[62:63]
    v_cndmask_b32 v12, v6, v12, s[64:65]
    v_cndmask_b32 v13, v6, v13, s[66:67]
    v_cndmask_b32 v14, v6, v14, s[68:69]
    v_cndmask_b32 v15, v6, v15, s[70:71]
    v_cndmask_b32 v16, v6, v16, s[72:73]
    v_cndmask_b32 v17, v6, v17, s[74:75]
    v_cndmask_b32 v18, v6, v18, s[76:77]
    v_cndmask_b32 v19, v6, v19, s[78:79]
    v_cndmask_b32 v20, v6, v20, s[80:81]
    v_cndmask_b32 v21, v6, v21, s[82:83]
    v_cndmask_b32 v22, v6, v22, s[84:85]
    v_cndmask_b32 v23, v6, v23, s[86:87]
L_s0_n0:
    s_cmp_lg_u32 s48, 8
    s_cbranch_scc1 L_s0_n8
    v_cndmask_b32 v8, v8, v6, s[56:57]
    v_cndmask_b32 v9, v9, v6, s[58:59]
    v_cndmask_b32 v10, v10, v6, s[60:61]
    v_cndmask_b32 v11, v11, v6, s[62:63]
    v_cndmask_b32 v12, v12, v6, s[64:65]
    v_cndmask_b32 v13, v13, v6, s[66:67]
    v_cndmask_b32 v14, v14, v6, s[68:69]
    v_cndmask_b32 v15, v15, v6, s[70:71]
    v_cndmask_b32 v16, v16, v6, s[72:73]
    v_cndmask_b32 v17, v17, v6, s[74:75]
    v_cndmask_b32 v18, v18, v6, s[76:77]
    v_cndmask_b32 v19, v19, v6, s[78:79]
    v_cndmask_b32 v20, v20, v6, s[80:81]
    v_cndmask_b32 v21, v21, v6, s[82:83]
    v_cndmask_b32 v22, v22, v6, s[84:85]
    v_cndmask_b32 v23, v23, v6, s[86:87]
L_s0_n8:
    s_cmp_lg_u32 s47, 0
    s_cbranch_scc1 L_s0_exp
    v_max3_f32 v1, v8, v9, v1
    v_max3_f32 v1, v10, v11, v1
    v_max3_f32 v1, v12, v13, v1
    v_max3_f32 v1, v14, v15, v1
    v_max3_f32 v1, v16, v17, v1
    v_max3_f32 v1, v18, v19, v1
    v_max3_f32 v1, v20, v21, v1
    v_max3_f32 v1, v22, v23, v1
    s_branch L_s0_next
L_s0_exp:
    v_sub_f32 v8, v8, v1
    v_sub_f32 v9, v9, v1
    v_sub_f32 v10, v10, v1
    v_sub_f32 v11, v11, v1
    v_sub_f32 v12, v12, v1
    v_sub_f32 v13, v13, v1
    v_sub_f32 v14, v14, v1
    v_sub_f32 v15, v15, v1
    v_sub_f32 v16, v16, v1
    v_sub_f32 v17, v17, v1
    v_sub_f32 v18, v18, v1
    v_sub_f32 v19, v19, v1
    v_sub_f32 v20, v20, v1
    v_sub_f32 v21, v21, v1
    v_sub_f32 v22, v22, v1
    v_sub_f32 v23, v23, v1
    v_exp_f32 v8, v8
    v_exp_f32 v9, v9
    v_exp_f32 v10, v10
    v_exp_f32 v11, v11
    v_exp_f32 v12, v12
    v_exp_f32 v13, v13
    v_exp_f32 v14, v14
    v_exp_f32 v15, v15
    v_exp_f32 v16, v16
    v_exp_f32 v17, v17
    v_exp_f32 v18, v18
    v_exp_f32 v19, v19
    v_exp_f32 v20, v20
    v_exp_f32 v21, v21
    v_exp_f32 v22, v22
    v_exp_f32 v23, v23
    v_cvt_pk_bf16_f32 v224, v8, v9
    v_cvt_pk_bf16_f32 v225, v10, v11
    v_cvt_pk_bf16_f32 v226, v12, v13
    v_cvt_pk_bf16_f32 v227, v14, v15
    v_cvt_pk_bf16_f32 v228, v16, v17
    v_cvt_pk_bf16_f32 v229, v18, v19
    v_cvt_pk_bf16_f32 v230, v20, v21
    v_cvt_pk_bf16_f32 v231, v22, v23
    v_mfma_f32_32x32x16_bf16 v[208:223], v[240:243], v[224:227], v[208:223]
    s_nop 0
    v_mfma_f32_32x32x16_bf16 v[208:223], v[244:247], v[228:231], v[208:223]
L_s0_next:
    s_add_u32 s48, s48, 1
    s_cmp_le_u32 s48, 8
    s_cbranch_scc1 L_s0_tile
    s_nop 15
    s_cmp_lg_u32 s47, 0
    s_cbranch_scc1 L_s0_done
    v_mov_b32 v2, v1
    s_nop 1
    v_permlane32_swap_b32 v2, v1
    v_max_f32 v1, v1, v2
    s_mov_b32 s47, 1
    s_branch L_s0_pass
L_s0_done:
    v_rcp_f32 v3, v220
    s_nop 0
    v_mul_f32 v208, v3, v208
    v_mul_f32 v209, v3, v209
    v_mul_f32 v210, v3, v210
    v_mul_f32 v211, v3, v211
    v_mul_f32 v212, v3, v212
    v_mul_f32 v213, v3, v213
    v_mul_f32 v214, v3, v214
    v_mul_f32 v215, v3, v215
    v_mul_f32 v216, v3, v216
    v_mul_f32 v217, v3, v217
    v_mul_f32 v218, v3, v218
    v_mul_f32 v219, v3, v219
    v_cvt_pk_bf16_f32 v208, v208, v209
    v_cvt_pk_bf16_f32 v209, v210, v211
    v_cvt_pk_bf16_f32 v210, v212, v213
    v_cvt_pk_bf16_f32 v211, v214, v215
    v_cvt_pk_bf16_f32 v60, v216, v217
    v_cvt_pk_bf16_f32 v61, v218, v219
    v_min_u32 v208, -2, v208
    v_min_u32 v209, -2, v209
    v_min_u32 v210, -2, v210
    v_min_u32 v211, -2, v211
    v_min_u32 v60, -2, v60
    v_min_u32 v61, -2, v61
    buffer_store_dwordx4 v[208:211], v0, s[20:23], s96 offen sc1
    s_nop 1
    s_branch L_back0
L_slow1:
    s_nop 15
    v_mov_b32 v6, 0x3f80
    v_cndmask_b32 v106, v106, v6, s[90:91]
    v_mov_b32 v6, 0xff800000
    v_mov_b32 v1, v6
    s_sub_i32 s49, 8, s46
    s_max_i32 s49, s49, 0
    s_mov_b32 s47, 0
    v_mov_b32 v64, 0
    v_mov_b32 v65, 0
    v_mov_b32 v66, 0
    v_mov_b32 v67, 0
    v_mov_b32 v68, 0
    v_mov_b32 v69, 0
    v_mov_b32 v70, 0
    v_mov_b32 v71, 0
    v_mov_b32 v72, 0
    v_mov_b32 v73, 0
    v_mov_b32 v74, 0
    v_mov_b32 v75, 0
    v_mov_b32 v76, 0
    v_mov_b32 v77, 0
    v_mov_b32 v78, 0
    v_mov_b32 v79, 0
L_s1_pass:
    s_mov_b32 s48, s49
L_s1_tile:
    s_mul_i32 s50, s48, 5152
    s_nop 15
    v_add_u32 v24, s50, v125
    v_add_u32 v25, s50, v127
    v_add_u32 v26, s50, v120
    v_add_u32 v27, s50, v121
    v_add_u32 v28, s50, v122
    v_add_u32 v29, s50, v123
    ds_read_b128 v[48:51], v24
    ds_read_b64 v[42:43], v25
    ds_read_b64_tr_b16 v[240:241], v26
    ds_read_b64_tr_b16 v[242:243], v27
    ds_read_b64_tr_b16 v[244:245], v28
    ds_read_b64_tr_b16 v[246:247], v29
    s_waitcnt lgkmcnt(0)
    v_mfma_f32_32x32x16_bf16 v[8:23], v[48:51], v[100:103], 0
    v_mfma_f32_32x32x8_bf16 v[8:23], v[42:43], v[106:107], v[8:23]
    s_nop 15
    s_cmp_lg_u32 s48, 0
    s_cbranch_scc1 L_s1_n0
    v_cndmask_b32 v8, v6, v8, s[56:57]
    v_cndmask_b32 v9, v6, v9, s[58:59]
    v_cndmask_b32 v10, v6, v10, s[60:61]
    v_cndmask_b32 v11, v6, v11, s[62:63]
    v_cndmask_b32 v12, v6, v12, s[64:65]
    v_cndmask_b32 v13, v6, v13, s[66:67]
    v_cndmask_b32 v14, v6, v14, s[68:69]
    v_cndmask_b32 v15, v6, v15, s[70:71]
    v_cndmask_b32 v16, v6, v16, s[72:73]
    v_cndmask_b32 v17, v6, v17, s[74:75]
    v_cndmask_b32 v18, v6, v18, s[76:77]
    v_cndmask_b32 v19, v6, v19, s[78:79]
    v_cndmask_b32 v20, v6, v20, s[80:81]
    v_cndmask_b32 v21, v6, v21, s[82:83]
    v_cndmask_b32 v22, v6, v22, s[84:85]
    v_cndmask_b32 v23, v6, v23, s[86:87]
L_s1_n0:
    s_cmp_lg_u32 s48, 8
    s_cbranch_scc1 L_s1_n8
    v_cndmask_b32 v8, v8, v6, s[56:57]
    v_cndmask_b32 v9, v9, v6, s[58:59]
    v_cndmask_b32 v10, v10, v6, s[60:61]
    v_cndmask_b32 v11, v11, v6, s[62:63]
    v_cndmask_b32 v12, v12, v6, s[64:65]
    v_cndmask_b32 v13, v13, v6, s[66:67]
    v_cndmask_b32 v14, v14, v6, s[68:69]
    v_cndmask_b32 v15, v15, v6, s[70:71]
    v_cndmask_b32 v16, v16, v6, s[72:73]
    v_cndmask_b32 v17, v17, v6, s[74:75]
    v_cndmask_b32 v18, v18, v6, s[76:77]
    v_cndmask_b32 v19, v19, v6, s[78:79]
    v_cndmask_b32 v20, v20, v6, s[80:81]
    v_cndmask_b32 v21, v21, v6, s[82:83]
    v_cndmask_b32 v22, v22, v6, s[84:85]
    v_cndmask_b32 v23, v23, v6, s[86:87]
L_s1_n8:
    s_cmp_lg_u32 s47, 0
    s_cbranch_scc1 L_s1_exp
    v_max3_f32 v1, v8, v9, v1
    v_max3_f32 v1, v10, v11, v1
    v_max3_f32 v1, v12, v13, v1
    v_max3_f32 v1, v14, v15, v1
    v_max3_f32 v1, v16, v17, v1
    v_max3_f32 v1, v18, v19, v1
    v_max3_f32 v1, v20, v21, v1
    v_max3_f32 v1, v22, v23, v1
    s_branch L_s1_next
L_s1_exp:
    v_sub_f32 v8, v8, v1
    v_sub_f32 v9, v9, v1
    v_sub_f32 v10, v10, v1
    v_sub_f32 v11, v11, v1
    v_sub_f32 v12, v12, v1
    v_sub_f32 v13, v13, v1
    v_sub_f32 v14, v14, v1
    v_sub_f32 v15, v15, v1
    v_sub_f32 v16, v16, v1
    v_sub_f32 v17, v17, v1
    v_sub_f32 v18, v18, v1
    v_sub_f32 v19, v19, v1
    v_sub_f32 v20, v20, v1
    v_sub_f32 v21, v21, v1
    v_sub_f32 v22, v22, v1
    v_sub_f32 v23, v23, v1
    v_exp_f32 v8, v8
    v_exp_f32 v9, v9
    v_exp_f32 v10, v10
    v_exp_f32 v11, v11
    v_exp_f32 v12, v12
    v_exp_f32 v13, v13
    v_exp_f32 v14, v14
    v_exp_f32 v15, v15
    v_exp_f32 v16, v16
    v_exp_f32 v17, v17
    v_exp_f32 v18, v18
    v_exp_f32 v19, v19
    v_exp_f32 v20, v20
    v_exp_f32 v21, v21
    v_exp_f32 v22, v22
    v_exp_f32 v23, v23
    v_cvt_pk_bf16_f32 v224, v8, v9
    v_cvt_pk_bf16_f32 v225, v10, v11
    v_cvt_pk_bf16_f32 v226, v12, v13
    v_cvt_pk_bf16_f32 v227, v14, v15
    v_cvt_pk_bf16_f32 v228, v16, v17
    v_cvt_pk_bf16_f32 v229, v18, v19
    v_cvt_pk_bf16_f32 v230, v20, v21
    v_cvt_pk_bf16_f32 v231, v22, v23
    v_mfma_f32_32x32x16_bf16 v[64:79], v[240:243], v[224:227], v[64:79]
    s_nop 0
    v_mfma_f32_32x32x16_bf16 v[64:79], v[244:247], v[228:231], v[64:79]
L_s1_next:
    s_add_u32 s48, s48, 1
    s_cmp_le_u32 s48, 8
    s_cbranch_scc1 L_s1_tile
    s_nop 15
    s_cmp_lg_u32 s47, 0
    s_cbranch_scc1 L_s1_done
    v_mov_b32 v2, v1
    s_nop 1
    v_permlane32_swap_b32 v2, v1
    v_max_f32 v1, v1, v2
    s_mov_b32 s47, 1
    s_branch L_s1_pass
L_s1_done:
    s_branch L_back1
L_fin:
    s_endpgm
.section .rodata,"a"
.p2align 6
.amdhsa_kernel parallel_sum__sliding_block__glu_gated_reglu__prompt_kernel
  .amdhsa_next_free_vgpr 256
  .amdhsa_next_free_sgpr 102
  .amdhsa_accum_offset 256
  .amdhsa_group_segment_fixed_size 0
  .amdhsa_kernarg_size 80
  .amdhsa_user_sgpr_count 2
  .amdhsa_user_sgpr_kernarg_segment_ptr 1
  .amdhsa_system_sgpr_workgroup_id_x 1
.end_amdhsa_kernel
```
